```python
import torch

def _softmax(x, axis=-1):
    return torch.softmax(x, dim=axis)
def _gelu(x):
    return torch.nn.functional.gelu(x, approximate="tanh")
def _silu(x):
    return torch.nn.functional.silu(x)
def _sigmoid(x):
    return torch.sigmoid(x)
def _layernorm(x, axis=-1, eps=1e-5):
    m = x.mean(dim=axis, keepdim=True)
    v = x.var(dim=axis, keepdim=True, unbiased=False)
    return (x - m) / torch.sqrt(v + eps)
def _scatter_add(tgt, idx, src, axis=0):
    return tgt.clone().index_add_(axis, idx, src)
def _segment_sum(src, seg, n):
    out = torch.zeros((n,) + src.shape[1:], dtype=src.dtype)
    return out.index_add_(0, seg, src)
def _pad(x, pw):
    flat = tuple(v for pair in reversed(pw) for v in pair)
    return torch.nn.functional.pad(x, flat)

kernel_name = 'concat_heads__gqa_block_cached__mha_block_cached__near_ridge'

def setup_inputs():

    _w = (lambda a: (lambda t: t.to(torch.bfloat16) if t.is_floating_point() else t)(torch.as_tensor(a)))
    def _A_setup():
        B, Sq, D = 8, 32, 1024
        Hq, Hkv, Sk, Dh = 32, 4, 1024, 128
        assert Hq % Hkv == 0, (Hq, Hkv)
        return {
            "x": _w((lambda *s: torch.randn(*s, dtype=torch.bfloat16) * 0.8)(B, Sq, D)),
            "k_cache": _w((lambda *s: torch.randn(*s, dtype=torch.bfloat16) * 0.8)(B, Hkv, Sk, Dh)),
            "v_cache": _w((lambda *s: torch.randn(*s, dtype=torch.bfloat16) * 0.05)(B, Hkv, Sk, Dh)),
            "wq": _w((lambda *s: torch.randn(*s, dtype=torch.bfloat16) * 0.8)(D, Hq * Dh) * (D ** -0.5)),
            "wo": _w((lambda *s: torch.randn(*s, dtype=torch.bfloat16) * 0.05)(Hq * Dh, D) * ((Hq * Dh) ** -0.5)),
        }
    _A_in = _A_setup()

    def _B_setup():
        B, Sq, D = 8, 32, 1024
        H, Sk, Dh = 32, 1024, 128
        return {
            "x": _w((lambda *s: torch.randn(*s, dtype=torch.bfloat16) * 0.8)(B, Sq, D)),
            "k_cache": _w((lambda *s: torch.randn(*s, dtype=torch.bfloat16) * 0.8)(B, H, Sk, Dh)),
            "v_cache": _w((lambda *s: torch.randn(*s, dtype=torch.bfloat16) * 0.05)(B, H, Sk, Dh)),
            "wq": _w((lambda *s: torch.randn(*s, dtype=torch.bfloat16) * 0.8)(D, H * Dh) * (D ** -0.5)),
            "wo": _w((lambda *s: torch.randn(*s, dtype=torch.bfloat16) * 0.05)(H * Dh, D) * ((H * Dh) ** -0.5)),
        }
    _B_in = _B_setup()

    return {
        "A_x": _A_in["x"],
        "A_k_cache": _A_in["k_cache"],
        "A_v_cache": _A_in["v_cache"],
        "A_wq": _A_in["wq"],
        "A_wo": _A_in["wo"],
        "B_x": _B_in["x"],
        "B_k_cache": _B_in["k_cache"],
        "B_v_cache": _B_in["v_cache"],
        "B_wq": _B_in["wq"],
        "B_wo": _B_in["wo"],
    }

def reference(A_x, A_k_cache, A_v_cache, A_wq, A_wo, B_x, B_k_cache, B_v_cache, B_wq, B_wo):
    def _A_ref(x, k_cache, v_cache, wq, wo):
        B, Sq, D = x.shape
        Hq, Dh = 32, 128
        Hkv = k_cache.shape[1]
        rep = Hq // Hkv
        q = (lambda x, *d: x.permute(*d))((x @ wq).reshape(B, Sq, Hq, Dh), 0, 2, 1, 3)
        k = (lambda x, n, axis: torch.repeat_interleave(x, n, dim=axis))(k_cache, rep, axis=1)
        v = (lambda x, n, axis: torch.repeat_interleave(x, n, dim=axis))(v_cache, rep, axis=1)
        scores = torch.einsum("bhqd,bhkd->bhqk", q, k) * (Dh ** -0.5)
        p = _softmax(scores, axis=-1)
        o = torch.einsum("bhqk,bhkd->bhqd", p, v)
        return (lambda x, *d: x.permute(*d))(o, 0, 2, 1, 3).reshape(B, Sq, Hq * Dh) @ wo

    def _B_ref(x, k_cache, v_cache, wq, wo):
        B, Sq, D = x.shape
        H, Dh = 32, 128
        q = (lambda x, *d: x.permute(*d))((x @ wq).reshape(B, Sq, H, Dh), 0, 2, 1, 3)
        scores = torch.einsum("bhqd,bhkd->bhqk", q, k_cache) * (Dh ** -0.5)
        p = _softmax(scores, axis=-1)
        o = torch.einsum("bhqk,bhkd->bhqd", p, v_cache)
        return (lambda x, *d: x.permute(*d))(o, 0, 2, 1, 3).reshape(B, Sq, H * Dh) @ wo

    a = _A_ref(A_x, A_k_cache, A_v_cache, A_wq, A_wo)
    b = _B_ref(B_x, B_k_cache, B_v_cache, B_wq, B_wo)
    return torch.concatenate([a, b], axis=-1)
```

```asm
; @launch grid=(256,1,1) block=(512,1,1) lds=163840
.amdgcn_target "amdgcn-amd-amdhsa--gfx950"
.text
.globl concat_heads__gqa_block_cached__mha_block_cached__near_ridge_kernel
.p2align 8
.type concat_heads__gqa_block_cached__mha_block_cached__near_ridge_kernel,@function
concat_heads__gqa_block_cached__mha_block_cached__near_ridge_kernel:
s_cmp_ge_u32 s2, 256
s_cbranch_scc1 L_end
s_load_dwordx16 s[8:23], s[0:1], 0
s_load_dwordx8 s[24:31], s[0:1], 64
s_load_dwordx2 s[32:33], s[0:1], 96
v_lshrrev_b32 v1, 6, v0
v_and_b32 v0, 63, v0
v_readfirstlane_b32 s3, v1
s_mov_b32 s34, 0x4000000
s_mov_b32 s35, 0x20000
s_mov_b32 s38, 0x4000000
s_mov_b32 s39, 0x20000
s_mov_b32 s42, 0x800000
s_mov_b32 s43, 0x20000
s_mov_b32 s46, 0x800000
s_mov_b32 s47, 0x20000
s_mov_b32 s50, 0x100000
s_mov_b32 s51, 0x20000
s_mov_b32 s54, 0x100
s_mov_b32 s55, 0x20000
s_mov_b32 s58, 0x10000000
s_mov_b32 s59, 0x20000
s_lshl_b32 s60, s3, 14
s_and_b32 s4, s2, 7
s_bfe_u32 s5, s2, 0x40003
v_lshlrev_b32 v25, 4, v0
v_bfe_u32 v30, v0, 4, 1
v_lshlrev_b32 v30, 2, v30
v_lshrrev_b32 v31, 5, v0
v_or_b32 v30, v30, v31
v_and_b32 v31, 7, v0
v_xor_b32 v30, v30, v31
v_lshlrev_b32 v30, 4, v30
v_xor_b32 v31, 32, v30
v_lshrrev_b32 v32, 3, v0
v_lshl_add_u32 v5, v32, 11, v30
v_lshl_add_u32 v6, v32, 11, v31
v_add_u32 v6, 15360, v6
v_lshl_add_u32 v7, v32, 11, v30
v_add_u32 v7, 30720, v7
v_lshl_add_u32 v8, v32, 11, v31
v_add_u32 v8, 46080, v8
v_lshl_add_u32 v9, v32, 13, v30
v_lshl_add_u32 v10, v32, 13, v31
v_add_u32 v10, 64512, v10
v_lshl_add_u32 v11, v32, 13, v30
v_add_u32 v11, 129024, v11
v_lshl_add_u32 v12, v32, 13, v31
v_add_u32 v12, 193536, v12
v_lshl_add_u32 v1, v32, 8, v30
v_lshl_add_u32 v2, v32, 8, v31
v_add_u32 v2, 1024, v2
v_lshl_add_u32 v3, v32, 8, v30
v_add_u32 v3, 2048, v3
v_lshl_add_u32 v4, v32, 8, v31
v_add_u32 v4, 3072, v4
s_cmp_ge_u32 s2, 128
s_cbranch_scc1 L_roleG
s_and_b32 s61, s5, 3
s_lshl_b32 s7, s4, 2
s_add_u32 s7, s7, s61
s_and_b32 s61, s5, 2
s_lshl_b32 s61, s61, 1
s_lshr_b32 s6, s5, 2
s_add_u32 s6, s6, s61
s_lshl_b32 s66, s5, 15
s_lshl_b32 s61, s3, 12
s_add_u32 s66, s66, s61
v_lshlrev_b32 v24, 6, v0
s_mul_i32 s61, s3, 0
s_add_u32 s61, s61, s5
s_and_b32 s61, s61, 7
s_lshl_b32 s62, s61, 2
s_and_b32 s63, s5, 8
s_lshl_b32 s63, s63, 1
s_add_u32 s62, s62, s63
s_and_b32 s63, s4, 1
s_lshl_b32 s63, s63, 1
s_add_u32 s62, s62, s63
s_add_u32 s62, s62, s3
s_add_u32 s62, s62, 8
s_and_b32 s62, s62, 31
s_lshl_b32 s67, s62, 18
s_and_b32 s63, s4, 3
s_lshl_b32 s63, s63, 3
s_add_u32 s61, s61, s63
s_lshl_b32 s61, s61, 8
s_add_u32 s67, s67, s61
v_lshrrev_b32 v21, 1, v0
v_lshlrev_b32 v21, 13, v21
v_and_b32 v22, 1, v0
v_lshl_add_u32 v21, v22, 7, v21
s_lshl_b32 s64, s6, 5
s_add_u32 s64, s64, s7
s_xor_b32 s65, s64, 128
s_xor_b32 s70, s6, 4
s_mov_b32 s98, 0x80000
s_mov_b32 s99, 0x20000
s_cmp_ge_u32 s4, 4
s_waitcnt lgkmcnt(0)
s_cselect_b32 s96, s8, s18
s_cselect_b32 s97, s9, s19
buffer_load_dword v23, v24, s[96:99], s66 offen
s_cselect_b32 s96, s14, s24
s_cselect_b32 s97, s15, s25
s_mov_b32 s98, 0x800000
buffer_load_dword v23, v21, s[96:99], s67 offen
s_mov_b32 s57, s33
s_mov_b32 s56, s32
s_mov_b32 s53, s31
s_mov_b32 s52, s30
s_mov_b32 s49, s29
s_mov_b32 s48, s28
s_mov_b32 s45, s27
s_mov_b32 s44, s26
s_mov_b32 s41, s25
s_mov_b32 s40, s24
s_mov_b32 s37, s23
s_mov_b32 s36, s22
s_mov_b32 s33, s21
s_mov_b32 s32, s20
s_lshl_b32 s81, s64, 18
s_lshl_b32 s61, s3, 13
s_add_u32 s81, s81, s61
s_add_u32 m0, s60, 0
s_add_u32 s93, s81, 0
buffer_load_dwordx4 v1, s[32:35], s93 offen offset:0 nt lds
buffer_load_dwordx4 v2, s[32:35], s93 offen offset:1024 nt lds
s_mov_b32 s29, s19
s_mov_b32 s28, s18
s_mov_b32 s30, 0x80000
s_mov_b32 s31, 0x20000
s_mov_b32 s25, s17
s_mov_b32 s24, s16
s_mov_b32 s26, 0x800000
s_mov_b32 s27, 0x20000
s_mov_b32 s21, s15
s_mov_b32 s20, s14
s_mov_b32 s22, 0x800000
s_mov_b32 s23, 0x20000
s_mov_b32 s17, s13
s_mov_b32 s16, s12
s_mov_b32 s18, 0x800000
s_mov_b32 s19, 0x20000
s_mov_b32 s13, s11
s_mov_b32 s12, s10
s_mov_b32 s14, 0x800000
s_mov_b32 s15, 0x20000
s_mov_b32 s10, 0x80000
s_mov_b32 s11, 0x20000
s_and_b32 s61, s4, 1
s_lshl_b32 s61, s61, 2
s_lshr_b32 s62, s5, 2
s_add_u32 s61, s61, s62
s_lshl_b32 s61, s61, 2
s_lshr_b32 s62, s4, 1
s_add_u32 s61, s61, s62
s_lshl_b32 s88, s61, 18
s_and_b32 s61, s5, 3
s_lshl_b32 s61, s61, 16
s_add_u32 s88, s88, s61
s_lshl_b32 s61, s3, 13
s_add_u32 s88, s88, s61
s_lshl_b32 s68, s6, 12
s_lshl_b32 s61, s7, 7
s_add_u32 s68, s68, s61
s_add_u32 s68, s68, 10518528
s_lshl_b32 s69, s70, 12
s_lshl_b32 s61, s7, 7
s_add_u32 s69, s69, s61
s_add_u32 s69, s69, 10518528
s_cmp_lg_u32 s3, 0
s_cbranch_scc1 L_clr_1
v_mov_b32 v255, 0
v_lshlrev_b32 v254, 2, v0
s_mov_b64 exec, 0xff
buffer_store_dword v255, v254, s[56:59], s68 offen sc1
s_mov_b64 exec, -1
v_lshlrev_b32 v254, 2, v0
s_mov_b64 exec, 0xff
buffer_store_dword v255, v254, s[56:59], s69 offen sc1
s_mov_b64 exec, -1
L_clr_1:
v_bfe_u32 v30, v0, 1, 1
v_lshlrev_b32 v30, 2, v30
v_bfe_u32 v31, v0, 2, 2
v_or_b32 v30, v30, v31
v_lshrrev_b32 v31, 5, v0
v_xor_b32 v30, v30, v31
v_lshlrev_b32 v30, 4, v30
v_and_b32 v31, 31, v0
v_lshl_add_u32 v30, v31, 7, v30
v_add_u32 v13, s60, v30
v_xor_b32 v14, 32, v13
v_xor_b32 v15, 64, v13
v_xor_b32 v16, 96, v13
v_bfe_u32 v30, v0, 1, 1
v_and_b32 v31, 1, v0
v_bfe_u32 v32, v0, 4, 1
v_lshl_add_u32 v30, v32, 1, v30
v_bfe_u32 v32, v0, 3, 1
v_lshlrev_b32 v32, 2, v32
v_xor_b32 v30, v30, v32
v_lshrrev_b32 v32, 5, v0
v_xor_b32 v30, v30, v32
v_lshlrev_b32 v30, 4, v30
v_lshl_add_u32 v30, v31, 3, v30
v_bfe_u32 v31, v0, 2, 2
v_lshl_add_u32 v31, v32, 2, v31
v_lshl_add_u32 v30, v31, 7, v30
v_add_u32 v17, s60, v30
v_xor_b32 v18, 32, v17
v_add_u32 v18, 1024, v18
v_xor_b32 v19, 64, v17
v_xor_b32 v20, 64, v18
s_lshl_b32 s72, s6, 12
s_lshl_b32 s61, s7, 7
s_add_u32 s72, s72, s61
s_add_u32 s72, s72, 10584064
s_lshl_b32 s66, s64, 13
s_add_u32 s71, s66, 6291456
s_add_u32 s66, s66, 2097152
s_xor_b32 s67, s66, 1048576
s_lshl_b32 s61, s3, 2
s_add_u32 s68, s68, s61
s_add_u32 s69, s69, s61
s_lshl_b32 s82, s65, 18
s_lshl_b32 s61, s3, 13
s_add_u32 s82, s82, s61
s_lshr_b32 s73, s5, 1
s_and_b32 s61, s5, 1
s_lshl_b32 s74, s4, 1
s_add_u32 s74, s74, s61
s_lshl_b32 s75, s73, 18
s_lshl_b32 s61, s3, 15
s_add_u32 s75, s75, s61
s_lshl_b32 s76, s73, 12
s_lshl_b32 s61, s3, 9
s_add_u32 s76, s76, s61
s_add_u32 s76, s76, 10485760
s_lshl_b32 s77, s73, 17
s_lshl_b32 s61, s74, 7
s_add_u32 s77, s77, s61
s_lshl_b32 s61, s73, 4
s_add_u32 s61, s61, s74
s_lshl_b32 s80, s61, 7
s_lshl_b32 s61, s61, 3
s_add_u32 s61, s61, s3
s_lshl_b32 s79, s61, 12
s_add_u32 s79, s79, 16777216
s_lshl_b32 s61, s3, 2
s_add_u32 s80, s80, s61
s_add_u32 s80, s80, 10616832
s_waitcnt vmcnt(3)
buffer_load_dwordx4 v3, s[32:35], s93 offen offset:2048 nt lds
s_waitcnt vmcnt(3)
buffer_load_dwordx4 v4, s[32:35], s93 offen offset:3072 nt lds
s_add_u32 m0, s60, 4096
s_add_u32 s93, s81, 128
s_waitcnt vmcnt(3)
buffer_load_dwordx4 v1, s[32:35], s93 offen offset:0 nt lds
s_waitcnt vmcnt(3)
buffer_load_dwordx4 v2, s[32:35], s93 offen offset:1024 nt lds
s_waitcnt vmcnt(3)
buffer_load_dwordx4 v3, s[32:35], s93 offen offset:2048 nt lds
s_waitcnt vmcnt(3)
buffer_load_dwordx4 v4, s[32:35], s93 offen offset:3072 nt lds
ds_read_b128 v[126:129], v13 offset:0
ds_read_b128 v[130:133], v14 offset:0
ds_read_b128 v[134:137], v15 offset:0
ds_read_b128 v[138:141], v16 offset:0
s_waitcnt lgkmcnt(0)
s_add_u32 m0, s60, 8192
s_add_u32 s93, s81, 65536
s_waitcnt vmcnt(3)
buffer_load_dwordx4 v1, s[32:35], s93 offen offset:0 nt lds
s_waitcnt vmcnt(3)
buffer_load_dwordx4 v2, s[32:35], s93 offen offset:1024 nt lds
s_waitcnt vmcnt(3)
buffer_load_dwordx4 v3, s[32:35], s93 offen offset:2048 nt lds
s_waitcnt vmcnt(3)
buffer_load_dwordx4 v4, s[32:35], s93 offen offset:3072 nt lds
s_cmp_lg_u32 s3, 0
s_cbranch_scc1 L_sig_2
v_mov_b32 v255, 1
s_mov_b64 exec, 1
s_and_b32 s61, s2, 63
s_lshl_b32 s61, s61, 2
buffer_atomic_add v255, off, s[52:55], s61 sc1
s_mov_b64 exec, -1
L_sig_2:
ds_read_b128 v[142:145], v13 offset:4096
ds_read_b128 v[146:149], v14 offset:4096
ds_read_b128 v[150:153], v15 offset:4096
ds_read_b128 v[154:157], v16 offset:4096
s_waitcnt lgkmcnt(0)
s_add_u32 m0, s60, 12288
s_add_u32 s93, s81, 65664
s_waitcnt vmcnt(3)
buffer_load_dwordx4 v1, s[32:35], s93 offen offset:0 nt lds
s_waitcnt vmcnt(3)
buffer_load_dwordx4 v2, s[32:35], s93 offen offset:1024 nt lds
s_waitcnt vmcnt(3)
buffer_load_dwordx4 v3, s[32:35], s93 offen offset:2048 nt lds
s_waitcnt vmcnt(3)
buffer_load_dwordx4 v4, s[32:35], s93 offen offset:3072 nt lds
ds_read_b128 v[158:161], v13 offset:8192
ds_read_b128 v[162:165], v14 offset:8192
ds_read_b128 v[166:169], v15 offset:8192
ds_read_b128 v[170:173], v16 offset:8192
s_waitcnt lgkmcnt(0)
s_add_u32 m0, s60, 0
s_add_u32 s93, s81, 131072
s_waitcnt vmcnt(3)
buffer_load_dwordx4 v1, s[32:35], s93 offen offset:0 nt lds
s_waitcnt vmcnt(3)
buffer_load_dwordx4 v2, s[32:35], s93 offen offset:1024 nt lds
s_waitcnt vmcnt(3)
buffer_load_dwordx4 v3, s[32:35], s93 offen offset:2048 nt lds
s_waitcnt vmcnt(3)
buffer_load_dwordx4 v4, s[32:35], s93 offen offset:3072 nt lds
ds_read_b128 v[174:177], v13 offset:12288
ds_read_b128 v[178:181], v14 offset:12288
ds_read_b128 v[182:185], v15 offset:12288
ds_read_b128 v[186:189], v16 offset:12288
s_waitcnt lgkmcnt(0)
s_add_u32 m0, s60, 4096
s_add_u32 s93, s81, 131200
s_waitcnt vmcnt(3)
buffer_load_dwordx4 v1, s[32:35], s93 offen offset:0 nt lds
s_waitcnt vmcnt(3)
buffer_load_dwordx4 v2, s[32:35], s93 offen offset:1024 nt lds
s_waitcnt vmcnt(3)
buffer_load_dwordx4 v3, s[32:35], s93 offen offset:2048 nt lds
s_waitcnt vmcnt(3)
buffer_load_dwordx4 v4, s[32:35], s93 offen offset:3072 nt lds
v_lshlrev_b32 v10, 2, v0
buffer_load_dword v10, v10, s[52:55], 0 offen sc1
ds_read_b128 v[190:193], v13 offset:0
ds_read_b128 v[194:197], v14 offset:0
ds_read_b128 v[198:201], v15 offset:0
ds_read_b128 v[202:205], v16 offset:0
s_waitcnt lgkmcnt(0)
s_add_u32 m0, s60, 8192
s_add_u32 s93, s81, 196608
s_waitcnt vmcnt(3)
buffer_load_dwordx4 v1, s[32:35], s93 offen offset:0 nt lds
s_waitcnt vmcnt(3)
buffer_load_dwordx4 v2, s[32:35], s93 offen offset:1024 nt lds
s_waitcnt vmcnt(3)
buffer_load_dwordx4 v3, s[32:35], s93 offen offset:2048 nt lds
ds_read_b128 v[206:209], v13 offset:4096
ds_read_b128 v[210:213], v14 offset:4096
ds_read_b128 v[214:217], v15 offset:4096
ds_read_b128 v[218:221], v16 offset:4096
s_waitcnt lgkmcnt(0)
s_waitcnt vmcnt(3)
buffer_load_dwordx4 v4, s[32:35], s93 offen offset:3072 nt lds
s_waitcnt vmcnt(3)
v_lshlrev_b32 v21, 7, v0
s_mov_b32 s89, s88
buffer_load_dword v23, v21, s[12:15], s89 offen
s_add_u32 m0, s60, 12288
s_add_u32 s93, s81, 196736
s_waitcnt vmcnt(3)
buffer_load_dwordx4 v1, s[32:35], s93 offen offset:0 nt lds
s_waitcnt vmcnt(3)
buffer_load_dwordx4 v2, s[32:35], s93 offen offset:1024 nt lds
s_waitcnt vmcnt(3)
buffer_load_dwordx4 v3, s[32:35], s93 offen offset:2048 nt lds
v_cmp_gt_u32 vcc, 4, v10
s_nop 4
s_cbranch_vccz L_ok_3
s_mov_b32 s62, 0
v_lshlrev_b32 v254, 2, v0
s_nop 4
L_pollc_4:
buffer_load_dword v255, v254, s[52:55], 0 offen sc1
s_waitcnt vmcnt(0)
v_cmp_gt_u32 vcc, 4, v255
s_add_u32 s62, s62, 1
s_nop 2
s_cbranch_vccz L_pcdone_5
s_cmp_lt_u32 s62, 200000
s_cbranch_scc0 L_pcdone_5
s_sleep 8
s_branch L_pollc_4
L_pcdone_5:
L_ok_3:
ds_read_b128 v[222:225], v13 offset:8192
ds_read_b128 v[226:229], v14 offset:8192
ds_read_b128 v[230:233], v15 offset:8192
ds_read_b128 v[234:237], v16 offset:8192
s_waitcnt lgkmcnt(0)
s_waitcnt vmcnt(3)
buffer_load_dwordx4 v4, s[32:35], s93 offen offset:3072 nt lds
s_add_u32 m0, s60, 0
s_add_u32 s93, s81, 0
s_waitcnt vmcnt(3)
buffer_load_dwordx4 v1, s[36:39], s93 offen offset:0 nt lds
s_waitcnt vmcnt(3)
buffer_load_dwordx4 v2, s[36:39], s93 offen offset:1024 nt lds
s_waitcnt vmcnt(3)
buffer_load_dwordx4 v3, s[36:39], s93 offen offset:2048 nt lds
s_waitcnt vmcnt(3)
buffer_load_dwordx4 v4, s[36:39], s93 offen offset:3072 nt lds
ds_read_b128 v[238:241], v13 offset:12288
ds_read_b128 v[242:245], v14 offset:12288
ds_read_b128 v[246:249], v15 offset:12288
ds_read_b128 v[250:253], v16 offset:12288
s_waitcnt lgkmcnt(0)
s_add_u32 m0, s60, 4096
s_add_u32 s93, s81, 128
s_waitcnt vmcnt(3)
buffer_load_dwordx4 v1, s[36:39], s93 offen offset:0 nt lds
s_waitcnt vmcnt(3)
buffer_load_dwordx4 v2, s[36:39], s93 offen offset:1024 nt lds
s_waitcnt vmcnt(3)
buffer_load_dwordx4 v3, s[36:39], s93 offen offset:2048 nt lds
s_waitcnt vmcnt(3)
buffer_load_dwordx4 v4, s[36:39], s93 offen offset:3072 nt lds
v_and_b32 v12, 1, v0
v_lshlrev_b32 v12, 2, v12
buffer_load_dword v10, v12, s[56:59], s72 offen sc1
s_add_u32 m0, s60, 8192
s_add_u32 s93, s81, 65536
s_waitcnt vmcnt(3)
buffer_load_dwordx4 v1, s[36:39], s93 offen offset:0 nt lds
s_waitcnt vmcnt(3)
buffer_load_dwordx4 v2, s[36:39], s93 offen offset:1024 nt lds
s_waitcnt vmcnt(3)
buffer_load_dwordx4 v3, s[36:39], s93 offen offset:2048 nt lds
s_waitcnt vmcnt(3)
buffer_load_dwordx4 v4, s[36:39], s93 offen offset:3072 nt lds
v_cmp_ne_u32 vcc, 1, v10
s_nop 4
s_cbranch_vccnz L_late_6
s_lshl_b32 s61, s3, 10
s_add_u32 s62, s61, 131072
s_add_u32 s61, s61, s71
s_mov_b32 s63, m0
s_mov_b32 m0, s62
s_nop 0
buffer_load_dwordx4 v25, s[56:59], s61 offen offset:0 sc1 lds
s_mov_b32 m0, s63
s_add_u32 m0, s60, 12288
s_add_u32 s93, s81, 65664
s_waitcnt vmcnt(3)
buffer_load_dwordx4 v1, s[36:39], s93 offen offset:0 nt lds
s_waitcnt vmcnt(3)
buffer_load_dwordx4 v2, s[36:39], s93 offen offset:1024 nt lds
s_waitcnt vmcnt(3)
buffer_load_dwordx4 v3, s[36:39], s93 offen offset:2048 nt lds
s_waitcnt vmcnt(3)
buffer_load_dwordx4 v4, s[36:39], s93 offen offset:3072 nt lds
s_nop 4
L_join_7:
v_add_u32 v254, 131072, v25
s_barrier
ds_read_b128 v[30:33], v254 offset:0
ds_read_b128 v[34:37], v254 offset:1024
ds_read_b128 v[38:41], v254 offset:2048
ds_read_b128 v[42:45], v254 offset:3072
ds_read_b128 v[46:49], v254 offset:4096
ds_read_b128 v[50:53], v254 offset:5120
ds_read_b128 v[54:57], v254 offset:6144
ds_read_b128 v[58:61], v254 offset:7168
s_waitcnt lgkmcnt(7)
v_mfma_f32_32x32x16_bf16 v[62:77], v[126:129], v[30:33], 0
s_waitcnt lgkmcnt(6)
v_mfma_f32_32x32x16_bf16 v[62:77], v[130:133], v[34:37], v[62:77]
s_waitcnt lgkmcnt(5)
v_mfma_f32_32x32x16_bf16 v[62:77], v[134:137], v[38:41], v[62:77]
s_waitcnt lgkmcnt(4)
v_mfma_f32_32x32x16_bf16 v[62:77], v[138:141], v[42:45], v[62:77]
s_waitcnt lgkmcnt(3)
v_mfma_f32_32x32x16_bf16 v[62:77], v[142:145], v[46:49], v[62:77]
s_waitcnt lgkmcnt(2)
v_mfma_f32_32x32x16_bf16 v[62:77], v[146:149], v[50:53], v[62:77]
s_waitcnt lgkmcnt(1)
v_mfma_f32_32x32x16_bf16 v[62:77], v[150:153], v[54:57], v[62:77]
s_waitcnt lgkmcnt(0)
v_mfma_f32_32x32x16_bf16 v[62:77], v[154:157], v[58:61], v[62:77]
v_mfma_f32_32x32x16_bf16 v[78:93], v[158:161], v[30:33], 0
v_mfma_f32_32x32x16_bf16 v[78:93], v[162:165], v[34:37], v[78:93]
v_mfma_f32_32x32x16_bf16 v[78:93], v[166:169], v[38:41], v[78:93]
v_mfma_f32_32x32x16_bf16 v[78:93], v[170:173], v[42:45], v[78:93]
v_mfma_f32_32x32x16_bf16 v[78:93], v[174:177], v[46:49], v[78:93]
v_mfma_f32_32x32x16_bf16 v[78:93], v[178:181], v[50:53], v[78:93]
v_mfma_f32_32x32x16_bf16 v[78:93], v[182:185], v[54:57], v[78:93]
v_mfma_f32_32x32x16_bf16 v[78:93], v[186:189], v[58:61], v[78:93]
v_mfma_f32_32x32x16_bf16 v[94:109], v[190:193], v[30:33], 0
v_mfma_f32_32x32x16_bf16 v[94:109], v[194:197], v[34:37], v[94:109]
v_mfma_f32_32x32x16_bf16 v[94:109], v[198:201], v[38:41], v[94:109]
v_mfma_f32_32x32x16_bf16 v[94:109], v[202:205], v[42:45], v[94:109]
v_mfma_f32_32x32x16_bf16 v[94:109], v[206:209], v[46:49], v[94:109]
v_mfma_f32_32x32x16_bf16 v[94:109], v[210:213], v[50:53], v[94:109]
v_mfma_f32_32x32x16_bf16 v[94:109], v[214:217], v[54:57], v[94:109]
v_mfma_f32_32x32x16_bf16 v[94:109], v[218:221], v[58:61], v[94:109]
v_mfma_f32_32x32x16_bf16 v[110:125], v[222:225], v[30:33], 0
v_mfma_f32_32x32x16_bf16 v[110:125], v[226:229], v[34:37], v[110:125]
v_mfma_f32_32x32x16_bf16 v[110:125], v[230:233], v[38:41], v[110:125]
v_mfma_f32_32x32x16_bf16 v[110:125], v[234:237], v[42:45], v[110:125]
v_mfma_f32_32x32x16_bf16 v[110:125], v[238:241], v[46:49], v[110:125]
v_mfma_f32_32x32x16_bf16 v[110:125], v[242:245], v[50:53], v[110:125]
v_mfma_f32_32x32x16_bf16 v[110:125], v[246:249], v[54:57], v[110:125]
v_mfma_f32_32x32x16_bf16 v[110:125], v[250:253], v[58:61], v[110:125]
ds_read_b64_tr_b16 v[158:159], v17 offset:0
ds_read_b64_tr_b16 v[160:161], v18 offset:0
ds_read_b64_tr_b16 v[162:163], v19 offset:0
ds_read_b64_tr_b16 v[164:165], v20 offset:0
ds_read_b64_tr_b16 v[166:167], v17 offset:2048
ds_read_b64_tr_b16 v[168:169], v18 offset:2048
ds_read_b64_tr_b16 v[170:171], v19 offset:2048
ds_read_b64_tr_b16 v[172:173], v20 offset:2048
s_waitcnt lgkmcnt(0)
ds_read_b64_tr_b16 v[222:223], v17 offset:4096
ds_read_b64_tr_b16 v[224:225], v18 offset:4096
ds_read_b64_tr_b16 v[226:227], v19 offset:4096
ds_read_b64_tr_b16 v[228:229], v20 offset:4096
ds_read_b64_tr_b16 v[230:231], v17 offset:6144
ds_read_b64_tr_b16 v[232:233], v18 offset:6144
ds_read_b64_tr_b16 v[234:235], v19 offset:6144
ds_read_b64_tr_b16 v[236:237], v20 offset:6144
s_waitcnt lgkmcnt(0)
ds_read_b64_tr_b16 v[238:239], v17 offset:8192
ds_read_b64_tr_b16 v[240:241], v18 offset:8192
ds_read_b64_tr_b16 v[242:243], v19 offset:8192
ds_read_b64_tr_b16 v[244:245], v20 offset:8192
ds_read_b64_tr_b16 v[246:247], v17 offset:10240
ds_read_b64_tr_b16 v[248:249], v18 offset:10240
ds_read_b64_tr_b16 v[250:251], v19 offset:10240
ds_read_b64_tr_b16 v[252:253], v20 offset:10240
s_waitcnt lgkmcnt(0)
v_and_b32 v255, 31, v0
v_lshlrev_b32 v255, 5, v255
v_add_u32 v255, 147456, v255
s_lshl_b32 s61, s3, 2
v_add_u32 v254, s61, v255
v_max3_f32 v30, v62, v63, v64
v_max3_f32 v31, v78, v79, v80
v_max3_f32 v32, v94, v95, v96
v_max3_f32 v33, v110, v111, v112
v_max3_f32 v30, v30, v65, v66
v_max3_f32 v31, v31, v81, v82
v_max3_f32 v32, v32, v97, v98
v_max3_f32 v33, v33, v113, v114
v_max3_f32 v30, v30, v67, v68
v_max3_f32 v31, v31, v83, v84
v_max3_f32 v32, v32, v99, v100
v_max3_f32 v33, v33, v115, v116
v_max3_f32 v30, v30, v69, v70
v_max3_f32 v31, v31, v85, v86
v_max3_f32 v32, v32, v101, v102
v_max3_f32 v33, v33, v117, v118
v_max3_f32 v30, v30, v71, v72
v_max3_f32 v31, v31, v87, v88
v_max3_f32 v32, v32, v103, v104
v_max3_f32 v33, v33, v119, v120
v_max3_f32 v30, v30, v73, v74
v_max3_f32 v31, v31, v89, v90
v_max3_f32 v32, v32, v105, v106
v_max3_f32 v33, v33, v121, v122
v_max3_f32 v30, v30, v75, v76
v_max3_f32 v31, v31, v91, v92
v_max3_f32 v32, v32, v107, v108
v_max3_f32 v33, v33, v123, v124
v_max3_f32 v30, v30, v77, v93
v_max3_f32 v31, v31, v109, v125
v_max3_f32 v30, v30, v32, v33
v_max_f32 v26, v30, v31
v_mov_b32 v30, v26
s_nop 1
v_permlane32_swap_b32 v26, v30
v_max_f32 v26, v26, v30
ds_write_b32 v254, v26 offset:0
s_add_u32 m0, s60, 0
s_add_u32 s93, s81, 131072
buffer_load_dwordx4 v1, s[36:39], s93 offen offset:0 nt lds
buffer_load_dwordx4 v2, s[36:39], s93 offen offset:1024 nt lds
s_waitcnt lgkmcnt(0)
s_barrier
ds_read_b128 v[30:33], v255 offset:0
ds_read_b128 v[34:37], v255 offset:16
s_waitcnt lgkmcnt(0)
v_max3_f32 v30, v30, v31, v32
v_max3_f32 v33, v33, v34, v35
v_max3_f32 v30, v30, v36, v37
v_max_f32 v26, v30, v33
v_sub_f32 v62, v62, v26
v_sub_f32 v63, v63, v26
v_sub_f32 v64, v64, v26
v_sub_f32 v65, v65, v26
v_sub_f32 v66, v66, v26
v_sub_f32 v67, v67, v26
v_sub_f32 v68, v68, v26
v_sub_f32 v69, v69, v26
v_exp_f32 v62, v62
v_exp_f32 v63, v63
v_exp_f32 v64, v64
v_exp_f32 v65, v65
v_exp_f32 v66, v66
v_exp_f32 v67, v67
v_exp_f32 v68, v68
v_exp_f32 v69, v69
v_add_f32 v30, v62, v66
v_add_f32 v31, v63, v67
v_add_f32 v32, v64, v68
v_add_f32 v33, v65, v69
v_cvt_pk_bf16_f32 v190, v62, v63
v_cvt_pk_bf16_f32 v191, v64, v65
v_cvt_pk_bf16_f32 v192, v66, v67
v_cvt_pk_bf16_f32 v193, v68, v69
s_waitcnt vmcnt(3)
buffer_load_dwordx4 v3, s[36:39], s93 offen offset:2048 nt lds
v_sub_f32 v70, v70, v26
v_sub_f32 v71, v71, v26
v_sub_f32 v72, v72, v26
v_sub_f32 v73, v73, v26
v_sub_f32 v74, v74, v26
v_sub_f32 v75, v75, v26
v_sub_f32 v76, v76, v26
v_sub_f32 v77, v77, v26
v_exp_f32 v70, v70
v_exp_f32 v71, v71
v_exp_f32 v72, v72
v_exp_f32 v73, v73
v_exp_f32 v74, v74
v_exp_f32 v75, v75
v_exp_f32 v76, v76
v_exp_f32 v77, v77
v_add_f32 v30, v30, v70
v_add_f32 v31, v31, v71
v_add_f32 v32, v32, v72
v_add_f32 v33, v33, v73
v_add_f32 v30, v30, v74
v_add_f32 v31, v31, v75
v_add_f32 v32, v32, v76
v_add_f32 v33, v33, v77
v_cvt_pk_bf16_f32 v194, v70, v71
v_cvt_pk_bf16_f32 v195, v72, v73
v_cvt_pk_bf16_f32 v196, v74, v75
v_cvt_pk_bf16_f32 v197, v76, v77
s_waitcnt vmcnt(3)
buffer_load_dwordx4 v4, s[36:39], s93 offen offset:3072 nt lds
v_sub_f32 v78, v78, v26
v_sub_f32 v79, v79, v26
v_sub_f32 v80, v80, v26
v_sub_f32 v81, v81, v26
v_sub_f32 v82, v82, v26
v_sub_f32 v83, v83, v26
v_sub_f32 v84, v84, v26
v_sub_f32 v85, v85, v26
v_exp_f32 v78, v78
v_exp_f32 v79, v79
v_exp_f32 v80, v80
v_exp_f32 v81, v81
v_exp_f32 v82, v82
v_exp_f32 v83, v83
v_exp_f32 v84, v84
v_exp_f32 v85, v85
v_add_f32 v30, v30, v78
v_add_f32 v31, v31, v79
v_add_f32 v32, v32, v80
v_add_f32 v33, v33, v81
v_add_f32 v30, v30, v82
v_add_f32 v31, v31, v83
v_add_f32 v32, v32, v84
v_add_f32 v33, v33, v85
v_cvt_pk_bf16_f32 v198, v78, v79
v_cvt_pk_bf16_f32 v199, v80, v81
v_cvt_pk_bf16_f32 v200, v82, v83
v_cvt_pk_bf16_f32 v201, v84, v85
s_add_u32 m0, s60, 4096
s_add_u32 s93, s81, 131200
s_waitcnt vmcnt(3)
buffer_load_dwordx4 v1, s[36:39], s93 offen offset:0 nt lds
v_sub_f32 v86, v86, v26
v_sub_f32 v87, v87, v26
v_sub_f32 v88, v88, v26
v_sub_f32 v89, v89, v26
v_sub_f32 v90, v90, v26
v_sub_f32 v91, v91, v26
v_sub_f32 v92, v92, v26
v_sub_f32 v93, v93, v26
v_exp_f32 v86, v86
v_exp_f32 v87, v87
v_exp_f32 v88, v88
v_exp_f32 v89, v89
v_exp_f32 v90, v90
v_exp_f32 v91, v91
v_exp_f32 v92, v92
v_exp_f32 v93, v93
v_add_f32 v30, v30, v86
v_add_f32 v31, v31, v87
v_add_f32 v32, v32, v88
v_add_f32 v33, v33, v89
v_add_f32 v30, v30, v90
v_add_f32 v31, v31, v91
v_add_f32 v32, v32, v92
v_add_f32 v33, v33, v93
v_cvt_pk_bf16_f32 v202, v86, v87
v_cvt_pk_bf16_f32 v203, v88, v89
v_cvt_pk_bf16_f32 v204, v90, v91
v_cvt_pk_bf16_f32 v205, v92, v93
s_waitcnt vmcnt(3)
buffer_load_dwordx4 v2, s[36:39], s93 offen offset:1024 nt lds
v_sub_f32 v94, v94, v26
v_sub_f32 v95, v95, v26
v_sub_f32 v96, v96, v26
v_sub_f32 v97, v97, v26
v_sub_f32 v98, v98, v26
v_sub_f32 v99, v99, v26
v_sub_f32 v100, v100, v26
v_sub_f32 v101, v101, v26
v_exp_f32 v94, v94
v_exp_f32 v95, v95
v_exp_f32 v96, v96
v_exp_f32 v97, v97
v_exp_f32 v98, v98
v_exp_f32 v99, v99
v_exp_f32 v100, v100
v_exp_f32 v101, v101
v_add_f32 v30, v30, v94
v_add_f32 v31, v31, v95
v_add_f32 v32, v32, v96
v_add_f32 v33, v33, v97
v_add_f32 v30, v30, v98
v_add_f32 v31, v31, v99
v_add_f32 v32, v32, v100
v_add_f32 v33, v33, v101
v_cvt_pk_bf16_f32 v206, v94, v95
v_cvt_pk_bf16_f32 v207, v96, v97
v_cvt_pk_bf16_f32 v208, v98, v99
v_cvt_pk_bf16_f32 v209, v100, v101
s_waitcnt vmcnt(3)
buffer_load_dwordx4 v3, s[36:39], s93 offen offset:2048 nt lds
v_sub_f32 v102, v102, v26
v_sub_f32 v103, v103, v26
v_sub_f32 v104, v104, v26
v_sub_f32 v105, v105, v26
v_sub_f32 v106, v106, v26
v_sub_f32 v107, v107, v26
v_sub_f32 v108, v108, v26
v_sub_f32 v109, v109, v26
v_exp_f32 v102, v102
v_exp_f32 v103, v103
v_exp_f32 v104, v104
v_exp_f32 v105, v105
v_exp_f32 v106, v106
v_exp_f32 v107, v107
v_exp_f32 v108, v108
v_exp_f32 v109, v109
v_add_f32 v30, v30, v102
v_add_f32 v31, v31, v103
v_add_f32 v32, v32, v104
v_add_f32 v33, v33, v105
v_add_f32 v30, v30, v106
v_add_f32 v31, v31, v107
v_add_f32 v32, v32, v108
v_add_f32 v33, v33, v109
v_cvt_pk_bf16_f32 v210, v102, v103
v_cvt_pk_bf16_f32 v211, v104, v105
v_cvt_pk_bf16_f32 v212, v106, v107
v_cvt_pk_bf16_f32 v213, v108, v109
s_waitcnt vmcnt(3)
buffer_load_dwordx4 v4, s[36:39], s93 offen offset:3072 nt lds
v_sub_f32 v110, v110, v26
v_sub_f32 v111, v111, v26
v_sub_f32 v112, v112, v26
v_sub_f32 v113, v113, v26
v_sub_f32 v114, v114, v26
v_sub_f32 v115, v115, v26
v_sub_f32 v116, v116, v26
v_sub_f32 v117, v117, v26
v_exp_f32 v110, v110
v_exp_f32 v111, v111
v_exp_f32 v112, v112
v_exp_f32 v113, v113
v_exp_f32 v114, v114
v_exp_f32 v115, v115
v_exp_f32 v116, v116
v_exp_f32 v117, v117
v_add_f32 v30, v30, v110
v_add_f32 v31, v31, v111
v_add_f32 v32, v32, v112
v_add_f32 v33, v33, v113
v_add_f32 v30, v30, v114
v_add_f32 v31, v31, v115
v_add_f32 v32, v32, v116
v_add_f32 v33, v33, v117
v_cvt_pk_bf16_f32 v214, v110, v111
v_cvt_pk_bf16_f32 v215, v112, v113
v_cvt_pk_bf16_f32 v216, v114, v115
v_cvt_pk_bf16_f32 v217, v116, v117
s_add_u32 m0, s60, 8192
s_add_u32 s93, s81, 196608
s_waitcnt vmcnt(3)
buffer_load_dwordx4 v1, s[36:39], s93 offen offset:0 nt lds
v_sub_f32 v118, v118, v26
v_sub_f32 v119, v119, v26
v_sub_f32 v120, v120, v26
v_sub_f32 v121, v121, v26
v_sub_f32 v122, v122, v26
v_sub_f32 v123, v123, v26
v_sub_f32 v124, v124, v26
v_sub_f32 v125, v125, v26
v_exp_f32 v118, v118
v_exp_f32 v119, v119
v_exp_f32 v120, v120
v_exp_f32 v121, v121
v_exp_f32 v122, v122
v_exp_f32 v123, v123
v_exp_f32 v124, v124
v_exp_f32 v125, v125
v_add_f32 v30, v30, v118
v_add_f32 v31, v31, v119
v_add_f32 v32, v32, v120
v_add_f32 v33, v33, v121
v_add_f32 v30, v30, v122
v_add_f32 v31, v31, v123
v_add_f32 v32, v32, v124
v_add_f32 v33, v33, v125
v_cvt_pk_bf16_f32 v218, v118, v119
v_cvt_pk_bf16_f32 v219, v120, v121
v_cvt_pk_bf16_f32 v220, v122, v123
v_cvt_pk_bf16_f32 v221, v124, v125
s_waitcnt vmcnt(3)
buffer_load_dwordx4 v2, s[36:39], s93 offen offset:1024 nt lds
v_add_f32 v30, v30, v31
v_add_f32 v32, v32, v33
v_add_f32 v28, v30, v32
v_mov_b32 v30, v28
s_nop 1
v_permlane32_swap_b32 v28, v30
v_add_f32 v28, v28, v30
ds_write_b32 v254, v28 offset:1024
s_waitcnt lgkmcnt(0)
s_xor_b32 s72, s72, 16384
s_xor_b32 s71, s71, 1048576
v_and_b32 v12, 1, v0
v_lshlrev_b32 v12, 2, v12
buffer_load_dword v10, v12, s[56:59], s72 offen sc1
s_waitcnt lgkmcnt(0)
v_mfma_f32_32x32x16_bf16 v[126:141], v[158:161], v[190:193], 0
v_mfma_f32_32x32x16_bf16 v[142:157], v[162:165], v[190:193], 0
v_mfma_f32_32x32x16_bf16 v[126:141], v[166:169], v[194:197], v[126:141]
v_mfma_f32_32x32x16_bf16 v[142:157], v[170:173], v[194:197], v[142:157]
v_mfma_f32_32x32x16_bf16 v[158:173], v[222:225], v[190:193], 0
v_mfma_f32_32x32x16_bf16 v[174:189], v[226:229], v[190:193], 0
v_mfma_f32_32x32x16_bf16 v[158:173], v[230:233], v[194:197], v[158:173]
v_mfma_f32_32x32x16_bf16 v[174:189], v[234:237], v[194:197], v[174:189]
v_mfma_f32_32x32x16_bf16 v[126:141], v[238:241], v[198:201], v[126:141]
v_mfma_f32_32x32x16_bf16 v[142:157], v[242:245], v[198:201], v[142:157]
v_mfma_f32_32x32x16_bf16 v[126:141], v[246:249], v[202:205], v[126:141]
v_mfma_f32_32x32x16_bf16 v[142:157], v[250:253], v[202:205], v[142:157]
ds_read_b64_tr_b16 v[46:47], v17 offset:12288
ds_read_b64_tr_b16 v[48:49], v18 offset:12288
ds_read_b64_tr_b16 v[50:51], v19 offset:12288
ds_read_b64_tr_b16 v[52:53], v20 offset:12288
ds_read_b64_tr_b16 v[54:55], v17 offset:14336
ds_read_b64_tr_b16 v[56:57], v18 offset:14336
ds_read_b64_tr_b16 v[58:59], v19 offset:14336
ds_read_b64_tr_b16 v[60:61], v20 offset:14336
s_waitcnt lgkmcnt(6)
v_mfma_f32_32x32x16_bf16 v[158:173], v[46:49], v[198:201], v[158:173]
s_waitcnt lgkmcnt(4)
v_mfma_f32_32x32x16_bf16 v[174:189], v[50:53], v[198:201], v[174:189]
s_waitcnt lgkmcnt(2)
v_mfma_f32_32x32x16_bf16 v[158:173], v[54:57], v[202:205], v[158:173]
s_waitcnt lgkmcnt(0)
v_mfma_f32_32x32x16_bf16 v[174:189], v[58:61], v[202:205], v[174:189]
ds_read_b64_tr_b16 v[30:31], v17 offset:0
ds_read_b64_tr_b16 v[32:33], v18 offset:0
ds_read_b64_tr_b16 v[34:35], v19 offset:0
ds_read_b64_tr_b16 v[36:37], v20 offset:0
ds_read_b64_tr_b16 v[38:39], v17 offset:2048
ds_read_b64_tr_b16 v[40:41], v18 offset:2048
ds_read_b64_tr_b16 v[42:43], v19 offset:2048
ds_read_b64_tr_b16 v[44:45], v20 offset:2048
s_waitcnt lgkmcnt(6)
v_mfma_f32_32x32x16_bf16 v[126:141], v[30:33], v[206:209], v[126:141]
s_waitcnt lgkmcnt(4)
v_mfma_f32_32x32x16_bf16 v[142:157], v[34:37], v[206:209], v[142:157]
s_waitcnt lgkmcnt(2)
v_mfma_f32_32x32x16_bf16 v[126:141], v[38:41], v[210:213], v[126:141]
s_waitcnt lgkmcnt(0)
v_mfma_f32_32x32x16_bf16 v[142:157], v[42:45], v[210:213], v[142:157]
s_waitcnt vmcnt(3)
buffer_load_dwordx4 v3, s[36:39], s93 offen offset:2048 nt lds
ds_read_b64_tr_b16 v[46:47], v17 offset:4096
ds_read_b64_tr_b16 v[48:49], v18 offset:4096
ds_read_b64_tr_b16 v[50:51], v19 offset:4096
ds_read_b64_tr_b16 v[52:53], v20 offset:4096
ds_read_b64_tr_b16 v[54:55], v17 offset:6144
ds_read_b64_tr_b16 v[56:57], v18 offset:6144
ds_read_b64_tr_b16 v[58:59], v19 offset:6144
ds_read_b64_tr_b16 v[60:61], v20 offset:6144
s_waitcnt lgkmcnt(6)
v_mfma_f32_32x32x16_bf16 v[158:173], v[46:49], v[206:209], v[158:173]
s_waitcnt lgkmcnt(4)
v_mfma_f32_32x32x16_bf16 v[174:189], v[50:53], v[206:209], v[174:189]
s_waitcnt lgkmcnt(2)
v_mfma_f32_32x32x16_bf16 v[158:173], v[54:57], v[210:213], v[158:173]
s_waitcnt lgkmcnt(0)
v_mfma_f32_32x32x16_bf16 v[174:189], v[58:61], v[210:213], v[174:189]
s_waitcnt vmcnt(3)
buffer_load_dwordx4 v4, s[36:39], s93 offen offset:3072 nt lds
s_add_u32 m0, s60, 12288
s_add_u32 s93, s81, 196736
s_waitcnt vmcnt(3)
buffer_load_dwordx4 v1, s[36:39], s93 offen offset:0 nt lds
s_waitcnt vmcnt(3)
buffer_load_dwordx4 v2, s[36:39], s93 offen offset:1024 nt lds
s_waitcnt vmcnt(3)
buffer_load_dwordx4 v3, s[36:39], s93 offen offset:2048 nt lds
s_waitcnt vmcnt(3)
buffer_load_dwordx4 v4, s[36:39], s93 offen offset:3072 nt lds
ds_read_b64_tr_b16 v[30:31], v17 offset:8192
ds_read_b64_tr_b16 v[32:33], v18 offset:8192
ds_read_b64_tr_b16 v[34:35], v19 offset:8192
ds_read_b64_tr_b16 v[36:37], v20 offset:8192
ds_read_b64_tr_b16 v[38:39], v17 offset:10240
ds_read_b64_tr_b16 v[40:41], v18 offset:10240
ds_read_b64_tr_b16 v[42:43], v19 offset:10240
ds_read_b64_tr_b16 v[44:45], v20 offset:10240
s_waitcnt lgkmcnt(6)
v_mfma_f32_32x32x16_bf16 v[126:141], v[30:33], v[214:217], v[126:141]
s_waitcnt lgkmcnt(4)
v_mfma_f32_32x32x16_bf16 v[142:157], v[34:37], v[214:217], v[142:157]
s_waitcnt lgkmcnt(2)
v_mfma_f32_32x32x16_bf16 v[126:141], v[38:41], v[218:221], v[126:141]
s_waitcnt lgkmcnt(0)
v_mfma_f32_32x32x16_bf16 v[142:157], v[42:45], v[218:221], v[142:157]
v_add_u32 v226, s60, v25
s_lshl_b32 s61, s3, 10
v_add_u32 v227, s61, v25
v_add_u32 v228, 0x10000, v227
v_and_b32 v229, 31, v0
v_lshlrev_b32 v229, 5, v229
v_add_u32 v229, 148480, v229
v_bfe_u32 v254, v0, 2, 1
v_lshrrev_b32 v255, 5, v0
v_xor_b32 v254, v254, v255
v_bfe_u32 v255, v0, 4, 1
v_or_b32 v254, v254, v255
v_lshlrev_b32 v254, 2, v254
v_bfe_u32 v255, v0, 3, 1
v_lshl_add_u32 v254, v255, 1, v254
v_bfe_u32 v255, v0, 1, 1
v_add_u32 v254, v254, v255
v_and_b32 v255, 1, v0
v_lshlrev_b32 v255, 4, v255
v_mov_b32 v222, 0x3f80
v_lshlrev_b32 v255, v255, v222
v_cmp_eq_u32 vcc, 0, v254
s_nop 1
v_cndmask_b32 v222, 0, v255, vcc
v_cmp_eq_u32 vcc, 1, v254
s_nop 1
v_cndmask_b32 v223, 0, v255, vcc
v_cmp_eq_u32 vcc, 2, v254
s_nop 1
v_cndmask_b32 v224, 0, v255, vcc
v_cmp_eq_u32 vcc, 3, v254
s_nop 1
v_cndmask_b32 v225, 0, v255, vcc
v_cvt_pk_bf16_f32 v94, v126, v127
v_cvt_pk_bf16_f32 v95, v128, v129
v_cvt_pk_bf16_f32 v96, v130, v131
v_cvt_pk_bf16_f32 v97, v132, v133
v_cvt_pk_bf16_f32 v98, v134, v135
v_cvt_pk_bf16_f32 v99, v136, v137
v_cvt_pk_bf16_f32 v100, v138, v139
v_cvt_pk_bf16_f32 v101, v140, v141
v_cvt_pk_bf16_f32 v102, v142, v143
v_cvt_pk_bf16_f32 v103, v144, v145
v_cvt_pk_bf16_f32 v104, v146, v147
v_cvt_pk_bf16_f32 v105, v148, v149
v_cvt_pk_bf16_f32 v106, v150, v151
v_cvt_pk_bf16_f32 v107, v152, v153
v_cvt_pk_bf16_f32 v108, v154, v155
v_cvt_pk_bf16_f32 v109, v156, v157
ds_write_b128 v226, v[94:97] offset:8192
ds_write_b128 v226, v[98:101] offset:9216
ds_write_b128 v226, v[102:105] offset:10240
ds_write_b128 v226, v[106:109] offset:11264
s_waitcnt lgkmcnt(0)
s_waitcnt vmcnt(3)
v_lshrrev_b32 v21, 1, v0
v_lshlrev_b32 v21, 11, v21
v_and_b32 v22, 1, v0
v_lshl_add_u32 v21, v22, 7, v21
s_lshl_b32 s89, s5, 3
s_add_u32 s89, s89, s3
s_lshl_b32 s89, s89, 16
s_lshl_b32 s61, s4, 8
s_add_u32 s89, s89, s61
buffer_load_dword v23, v21, s[44:47], s89 offen
s_add_u32 m0, s60, 0
s_add_u32 s93, s82, 0
s_waitcnt vmcnt(3)
buffer_load_dwordx4 v1, s[32:35], s93 offen offset:0 nt lds
s_waitcnt vmcnt(3)
buffer_load_dwordx4 v2, s[32:35], s93 offen offset:1024 nt lds
s_waitcnt vmcnt(3)
buffer_load_dwordx4 v3, s[32:35], s93 offen offset:2048 nt lds
ds_read_b64_tr_b16 v[46:47], v17 offset:12288
ds_read_b64_tr_b16 v[48:49], v18 offset:12288
ds_read_b64_tr_b16 v[50:51], v19 offset:12288
ds_read_b64_tr_b16 v[52:53], v20 offset:12288
ds_read_b64_tr_b16 v[54:55], v17 offset:14336
ds_read_b64_tr_b16 v[56:57], v18 offset:14336
ds_read_b64_tr_b16 v[58:59], v19 offset:14336
ds_read_b64_tr_b16 v[60:61], v20 offset:14336
s_waitcnt lgkmcnt(6)
v_mfma_f32_32x32x16_bf16 v[158:173], v[46:49], v[214:217], v[158:173]
s_waitcnt lgkmcnt(4)
v_mfma_f32_32x32x16_bf16 v[174:189], v[50:53], v[214:217], v[174:189]
s_waitcnt lgkmcnt(2)
v_mfma_f32_32x32x16_bf16 v[158:173], v[54:57], v[218:221], v[158:173]
s_waitcnt lgkmcnt(0)
v_mfma_f32_32x32x16_bf16 v[174:189], v[58:61], v[218:221], v[174:189]
s_nop 9
v_cvt_pk_bf16_f32 v110, v158, v159
v_cvt_pk_bf16_f32 v111, v160, v161
v_cvt_pk_bf16_f32 v112, v162, v163
v_cvt_pk_bf16_f32 v113, v164, v165
v_cvt_pk_bf16_f32 v114, v166, v167
v_cvt_pk_bf16_f32 v115, v168, v169
v_cvt_pk_bf16_f32 v116, v170, v171
v_cvt_pk_bf16_f32 v117, v172, v173
v_cvt_pk_bf16_f32 v118, v174, v175
v_cvt_pk_bf16_f32 v119, v176, v177
v_cvt_pk_bf16_f32 v120, v178, v179
v_cvt_pk_bf16_f32 v121, v180, v181
v_cvt_pk_bf16_f32 v122, v182, v183
v_cvt_pk_bf16_f32 v123, v184, v185
v_cvt_pk_bf16_f32 v124, v186, v187
v_cvt_pk_bf16_f32 v125, v188, v189
ds_write_b128 v226, v[110:113] offset:12288
ds_write_b128 v226, v[114:117] offset:13312
ds_write_b128 v226, v[118:121] offset:14336
ds_write_b128 v226, v[122:125] offset:15360
buffer_load_dwordx4 v4, s[32:35], s93 offen offset:3072 nt lds
s_add_u32 m0, s60, 4096
s_add_u32 s93, s82, 128
buffer_load_dwordx4 v1, s[32:35], s93 offen offset:0 nt lds
s_waitcnt lgkmcnt(0)
s_barrier
ds_read_b128 v[174:177], v229 offset:0
ds_read_b128 v[178:181], v229 offset:16
ds_read_b128 v[126:129], v227 offset:8192
ds_read_b128 v[130:133], v227 offset:24576
ds_read_b128 v[134:137], v227 offset:40960
ds_read_b128 v[138:141], v227 offset:57344
ds_read_b128 v[142:145], v228 offset:8192
ds_read_b128 v[146:149], v228 offset:24576
ds_read_b128 v[150:153], v228 offset:40960
ds_read_b128 v[154:157], v228 offset:57344
s_mov_b32 s62, 0
s_nop 4
L_chk_10:
v_cmp_ne_u32 vcc, 1, v10
s_add_u32 s62, s62, 1
s_nop 2
s_cbranch_vccz L_ok_11
s_cmp_lt_u32 s62, 200000
s_cbranch_scc0 L_ok_11
s_sleep 8
buffer_load_dword v10, v12, s[56:59], s72 offen sc1
s_waitcnt vmcnt(0)
s_branch L_chk_10
L_ok_11:
s_lshl_b32 s61, s3, 10
s_add_u32 s62, s61, 131072
s_add_u32 s61, s61, s71
s_mov_b32 s63, m0
s_mov_b32 m0, s62
s_nop 0
buffer_load_dwordx4 v25, s[56:59], s61 offen offset:0 sc1 lds
s_mov_b32 m0, s63
s_waitcnt lgkmcnt(8)
v_add_f32 v174, v174, v175
v_add_f32 v176, v176, v177
v_add_f32 v178, v178, v179
v_add_f32 v180, v180, v181
v_add_f32 v174, v174, v176
v_add_f32 v178, v178, v180
v_add_f32 v174, v174, v178
v_rcp_f32 v174, v174
s_waitcnt lgkmcnt(7)
v_mfma_f32_32x32x16_bf16 v[158:173], v[222:225], v[126:129], 0
s_waitcnt lgkmcnt(6)
v_mfma_f32_32x32x16_bf16 v[158:173], v[222:225], v[130:133], v[158:173]
s_waitcnt lgkmcnt(5)
v_mfma_f32_32x32x16_bf16 v[158:173], v[222:225], v[134:137], v[158:173]
s_waitcnt lgkmcnt(4)
v_mfma_f32_32x32x16_bf16 v[158:173], v[222:225], v[138:141], v[158:173]
s_waitcnt lgkmcnt(3)
v_mfma_f32_32x32x16_bf16 v[158:173], v[222:225], v[142:145], v[158:173]
s_waitcnt lgkmcnt(2)
v_mfma_f32_32x32x16_bf16 v[158:173], v[222:225], v[146:149], v[158:173]
s_waitcnt lgkmcnt(1)
v_mfma_f32_32x32x16_bf16 v[158:173], v[222:225], v[150:153], v[158:173]
s_waitcnt lgkmcnt(0)
v_mfma_f32_32x32x16_bf16 v[158:173], v[222:225], v[154:157], v[158:173]
s_nop 11
v_mul_f32 v158, v174, v158
v_mul_f32 v159, v174, v159
v_mul_f32 v160, v174, v160
v_mul_f32 v161, v174, v161
v_mul_f32 v162, v174, v162
v_mul_f32 v163, v174, v163
v_mul_f32 v164, v174, v164
v_mul_f32 v165, v174, v165
v_cvt_pk_bf16_f32 v166, v158, v159
v_cvt_pk_bf16_f32 v167, v160, v161
v_cvt_pk_bf16_f32 v168, v162, v163
v_cvt_pk_bf16_f32 v169, v164, v165
buffer_store_dwordx4 v[166:169], v227, s[56:59], s66 offen sc1
s_waitcnt vmcnt(0)
v_mov_b32 v254, 1
s_mov_b64 exec, 1
buffer_store_dword v254, off, s[56:59], s68 offset:0 sc1
s_mov_b64 exec, -1
s_barrier
buffer_load_dwordx4 v2, s[32:35], s93 offen offset:1024 nt lds
buffer_load_dwordx4 v3, s[32:35], s93 offen offset:2048 nt lds
buffer_load_dwordx4 v4, s[32:35], s93 offen offset:3072 nt lds
v_add_u32 v254, 131072, v25
s_barrier
ds_read_b128 v[62:65], v254 offset:0
ds_read_b128 v[66:69], v254 offset:1024
ds_read_b128 v[70:73], v254 offset:2048
ds_read_b128 v[74:77], v254 offset:3072
ds_read_b128 v[78:81], v254 offset:4096
ds_read_b128 v[82:85], v254 offset:5120
ds_read_b128 v[86:89], v254 offset:6144
ds_read_b128 v[90:93], v254 offset:7168
s_waitcnt lgkmcnt(0)
ds_read_b128 v[30:33], v13 offset:0
ds_read_b128 v[34:37], v14 offset:0
ds_read_b128 v[38:41], v15 offset:0
ds_read_b128 v[42:45], v16 offset:0
s_waitcnt lgkmcnt(3)
v_mfma_f32_32x32x16_bf16 v[126:141], v[30:33], v[62:65], 0
s_waitcnt lgkmcnt(2)
v_mfma_f32_32x32x16_bf16 v[126:141], v[34:37], v[66:69], v[126:141]
s_waitcnt lgkmcnt(1)
v_mfma_f32_32x32x16_bf16 v[126:141], v[38:41], v[70:73], v[126:141]
s_waitcnt lgkmcnt(0)
v_mfma_f32_32x32x16_bf16 v[126:141], v[42:45], v[74:77], v[126:141]
s_add_u32 m0, s60, 8192
s_add_u32 s93, s82, 65536
s_waitcnt vmcnt(3)
buffer_load_dwordx4 v1, s[32:35], s93 offen offset:0 nt lds
s_waitcnt vmcnt(3)
buffer_load_dwordx4 v2, s[32:35], s93 offen offset:1024 nt lds
s_waitcnt vmcnt(3)
buffer_load_dwordx4 v3, s[32:35], s93 offen offset:2048 nt lds
s_waitcnt vmcnt(3)
buffer_load_dwordx4 v4, s[32:35], s93 offen offset:3072 nt lds
ds_read_b128 v[46:49], v13 offset:4096
ds_read_b128 v[50:53], v14 offset:4096
ds_read_b128 v[54:57], v15 offset:4096
ds_read_b128 v[58:61], v16 offset:4096
s_waitcnt lgkmcnt(3)
v_mfma_f32_32x32x16_bf16 v[126:141], v[46:49], v[78:81], v[126:141]
s_waitcnt lgkmcnt(2)
v_mfma_f32_32x32x16_bf16 v[126:141], v[50:53], v[82:85], v[126:141]
s_waitcnt lgkmcnt(1)
v_mfma_f32_32x32x16_bf16 v[126:141], v[54:57], v[86:89], v[126:141]
s_waitcnt lgkmcnt(0)
v_mfma_f32_32x32x16_bf16 v[126:141], v[58:61], v[90:93], v[126:141]
s_add_u32 m0, s60, 12288
s_add_u32 s93, s82, 65664
s_waitcnt vmcnt(3)
buffer_load_dwordx4 v1, s[32:35], s93 offen offset:0 nt lds
s_waitcnt vmcnt(3)
buffer_load_dwordx4 v2, s[32:35], s93 offen offset:1024 nt lds
s_waitcnt vmcnt(3)
buffer_load_dwordx4 v3, s[32:35], s93 offen offset:2048 nt lds
s_waitcnt vmcnt(3)
buffer_load_dwordx4 v4, s[32:35], s93 offen offset:3072 nt lds
ds_read_b128 v[30:33], v13 offset:8192
ds_read_b128 v[34:37], v14 offset:8192
ds_read_b128 v[38:41], v15 offset:8192
ds_read_b128 v[42:45], v16 offset:8192
s_waitcnt lgkmcnt(3)
v_mfma_f32_32x32x16_bf16 v[142:157], v[30:33], v[62:65], 0
s_waitcnt lgkmcnt(2)
v_mfma_f32_32x32x16_bf16 v[142:157], v[34:37], v[66:69], v[142:157]
s_waitcnt lgkmcnt(1)
v_mfma_f32_32x32x16_bf16 v[142:157], v[38:41], v[70:73], v[142:157]
s_waitcnt lgkmcnt(0)
v_mfma_f32_32x32x16_bf16 v[142:157], v[42:45], v[74:77], v[142:157]
s_add_u32 m0, s60, 0
s_add_u32 s93, s82, 131072
s_waitcnt vmcnt(3)
buffer_load_dwordx4 v1, s[32:35], s93 offen offset:0 nt lds
s_waitcnt vmcnt(3)
buffer_load_dwordx4 v2, s[32:35], s93 offen offset:1024 nt lds
s_waitcnt vmcnt(3)
buffer_load_dwordx4 v3, s[32:35], s93 offen offset:2048 nt lds
s_waitcnt vmcnt(3)
buffer_load_dwordx4 v4, s[32:35], s93 offen offset:3072 nt lds
ds_read_b128 v[46:49], v13 offset:12288
ds_read_b128 v[50:53], v14 offset:12288
ds_read_b128 v[54:57], v15 offset:12288
ds_read_b128 v[58:61], v16 offset:12288
s_waitcnt lgkmcnt(3)
v_mfma_f32_32x32x16_bf16 v[142:157], v[46:49], v[78:81], v[142:157]
s_waitcnt lgkmcnt(2)
v_mfma_f32_32x32x16_bf16 v[142:157], v[50:53], v[82:85], v[142:157]
s_waitcnt lgkmcnt(1)
v_mfma_f32_32x32x16_bf16 v[142:157], v[54:57], v[86:89], v[142:157]
s_waitcnt lgkmcnt(0)
v_mfma_f32_32x32x16_bf16 v[142:157], v[58:61], v[90:93], v[142:157]
s_add_u32 m0, s60, 4096
s_add_u32 s93, s82, 131200
s_waitcnt vmcnt(3)
buffer_load_dwordx4 v1, s[32:35], s93 offen offset:0 nt lds
s_waitcnt vmcnt(3)
buffer_load_dwordx4 v2, s[32:35], s93 offen offset:1024 nt lds
s_waitcnt vmcnt(3)
buffer_load_dwordx4 v3, s[32:35], s93 offen offset:2048 nt lds
s_waitcnt vmcnt(3)
buffer_load_dwordx4 v4, s[32:35], s93 offen offset:3072 nt lds
ds_read_b128 v[30:33], v13 offset:0
ds_read_b128 v[34:37], v14 offset:0
ds_read_b128 v[38:41], v15 offset:0
ds_read_b128 v[42:45], v16 offset:0
s_waitcnt lgkmcnt(3)
v_mfma_f32_32x32x16_bf16 v[158:173], v[30:33], v[62:65], 0
s_waitcnt lgkmcnt(2)
v_mfma_f32_32x32x16_bf16 v[158:173], v[34:37], v[66:69], v[158:173]
s_waitcnt lgkmcnt(1)
v_mfma_f32_32x32x16_bf16 v[158:173], v[38:41], v[70:73], v[158:173]
s_waitcnt lgkmcnt(0)
v_mfma_f32_32x32x16_bf16 v[158:173], v[42:45], v[74:77], v[158:173]
s_add_u32 m0, s60, 8192
s_add_u32 s93, s82, 196608
s_waitcnt vmcnt(3)
buffer_load_dwordx4 v1, s[32:35], s93 offen offset:0 nt lds
s_waitcnt vmcnt(3)
buffer_load_dwordx4 v2, s[32:35], s93 offen offset:1024 nt lds
s_waitcnt vmcnt(3)
buffer_load_dwordx4 v3, s[32:35], s93 offen offset:2048 nt lds
s_waitcnt vmcnt(3)
buffer_load_dwordx4 v4, s[32:35], s93 offen offset:3072 nt lds
ds_read_b128 v[46:49], v13 offset:4096
ds_read_b128 v[50:53], v14 offset:4096
ds_read_b128 v[54:57], v15 offset:4096
ds_read_b128 v[58:61], v16 offset:4096
s_waitcnt lgkmcnt(3)
v_mfma_f32_32x32x16_bf16 v[158:173], v[46:49], v[78:81], v[158:173]
s_waitcnt lgkmcnt(2)
v_mfma_f32_32x32x16_bf16 v[158:173], v[50:53], v[82:85], v[158:173]
s_waitcnt lgkmcnt(1)
v_mfma_f32_32x32x16_bf16 v[158:173], v[54:57], v[86:89], v[158:173]
s_waitcnt lgkmcnt(0)
v_mfma_f32_32x32x16_bf16 v[158:173], v[58:61], v[90:93], v[158:173]
s_add_u32 m0, s60, 12288
s_add_u32 s93, s82, 196736
s_waitcnt vmcnt(3)
buffer_load_dwordx4 v1, s[32:35], s93 offen offset:0 nt lds
s_waitcnt vmcnt(3)
buffer_load_dwordx4 v2, s[32:35], s93 offen offset:1024 nt lds
s_waitcnt vmcnt(3)
buffer_load_dwordx4 v3, s[32:35], s93 offen offset:2048 nt lds
s_waitcnt vmcnt(3)
buffer_load_dwordx4 v4, s[32:35], s93 offen offset:3072 nt lds
ds_read_b128 v[30:33], v13 offset:8192
ds_read_b128 v[34:37], v14 offset:8192
ds_read_b128 v[38:41], v15 offset:8192
ds_read_b128 v[42:45], v16 offset:8192
s_waitcnt lgkmcnt(3)
v_mfma_f32_32x32x16_bf16 v[174:189], v[30:33], v[62:65], 0
s_waitcnt lgkmcnt(2)
v_mfma_f32_32x32x16_bf16 v[174:189], v[34:37], v[66:69], v[174:189]
s_waitcnt lgkmcnt(1)
v_mfma_f32_32x32x16_bf16 v[174:189], v[38:41], v[70:73], v[174:189]
s_waitcnt lgkmcnt(0)
v_mfma_f32_32x32x16_bf16 v[174:189], v[42:45], v[74:77], v[174:189]
s_add_u32 m0, s60, 0
s_add_u32 s93, s82, 0
s_waitcnt vmcnt(3)
buffer_load_dwordx4 v1, s[36:39], s93 offen offset:0 nt lds
s_waitcnt vmcnt(3)
buffer_load_dwordx4 v2, s[36:39], s93 offen offset:1024 nt lds
s_waitcnt vmcnt(3)
buffer_load_dwordx4 v3, s[36:39], s93 offen offset:2048 nt lds
s_waitcnt vmcnt(3)
buffer_load_dwordx4 v4, s[36:39], s93 offen offset:3072 nt lds
ds_read_b128 v[46:49], v13 offset:12288
ds_read_b128 v[50:53], v14 offset:12288
ds_read_b128 v[54:57], v15 offset:12288
ds_read_b128 v[58:61], v16 offset:12288
s_waitcnt lgkmcnt(3)
v_mfma_f32_32x32x16_bf16 v[174:189], v[46:49], v[78:81], v[174:189]
s_waitcnt lgkmcnt(2)
v_mfma_f32_32x32x16_bf16 v[174:189], v[50:53], v[82:85], v[174:189]
s_waitcnt lgkmcnt(1)
v_mfma_f32_32x32x16_bf16 v[174:189], v[54:57], v[86:89], v[174:189]
s_waitcnt lgkmcnt(0)
v_mfma_f32_32x32x16_bf16 v[174:189], v[58:61], v[90:93], v[174:189]
v_and_b32 v255, 31, v0
v_lshlrev_b32 v255, 5, v255
v_add_u32 v255, 147456, v255
s_lshl_b32 s61, s3, 2
v_add_u32 v254, s61, v255
v_max3_f32 v30, v126, v127, v128
v_max3_f32 v31, v142, v143, v144
v_max3_f32 v32, v158, v159, v160
s_nop 3
v_max3_f32 v33, v174, v175, v176
v_max3_f32 v30, v30, v129, v130
v_max3_f32 v31, v31, v145, v146
v_max3_f32 v32, v32, v161, v162
v_max3_f32 v33, v33, v177, v178
v_max3_f32 v30, v30, v131, v132
v_max3_f32 v31, v31, v147, v148
v_max3_f32 v32, v32, v163, v164
v_max3_f32 v33, v33, v179, v180
v_max3_f32 v30, v30, v133, v134
v_max3_f32 v31, v31, v149, v150
v_max3_f32 v32, v32, v165, v166
v_max3_f32 v33, v33, v181, v182
v_max3_f32 v30, v30, v135, v136
v_max3_f32 v31, v31, v151, v152
v_max3_f32 v32, v32, v167, v168
v_max3_f32 v33, v33, v183, v184
v_max3_f32 v30, v30, v137, v138
v_max3_f32 v31, v31, v153, v154
v_max3_f32 v32, v32, v169, v170
v_max3_f32 v33, v33, v185, v186
v_max3_f32 v30, v30, v139, v140
v_max3_f32 v31, v31, v155, v156
v_max3_f32 v32, v32, v171, v172
v_max3_f32 v33, v33, v187, v188
v_max3_f32 v30, v30, v141, v157
v_max3_f32 v31, v31, v173, v189
v_max3_f32 v30, v30, v32, v33
v_max_f32 v26, v30, v31
v_mov_b32 v30, v26
s_nop 1
v_permlane32_swap_b32 v26, v30
v_max_f32 v26, v26, v30
ds_write_b32 v254, v26 offset:0
s_add_u32 m0, s60, 4096
s_add_u32 s93, s82, 128
buffer_load_dwordx4 v1, s[36:39], s93 offen offset:0 nt lds
buffer_load_dwordx4 v2, s[36:39], s93 offen offset:1024 nt lds
s_waitcnt lgkmcnt(0)
s_barrier
ds_read_b128 v[30:33], v255 offset:0
ds_read_b128 v[34:37], v255 offset:16
s_waitcnt lgkmcnt(0)
v_max3_f32 v30, v30, v31, v32
v_max3_f32 v33, v33, v34, v35
v_max3_f32 v30, v30, v36, v37
v_max_f32 v26, v30, v33
v_sub_f32 v126, v126, v26
v_sub_f32 v127, v127, v26
v_sub_f32 v128, v128, v26
v_sub_f32 v129, v129, v26
v_sub_f32 v130, v130, v26
v_sub_f32 v131, v131, v26
v_sub_f32 v132, v132, v26
v_sub_f32 v133, v133, v26
v_exp_f32 v126, v126
v_exp_f32 v127, v127
v_exp_f32 v128, v128
v_exp_f32 v129, v129
v_exp_f32 v130, v130
v_exp_f32 v131, v131
v_exp_f32 v132, v132
v_exp_f32 v133, v133
v_add_f32 v30, v126, v130
v_add_f32 v31, v127, v131
v_add_f32 v32, v128, v132
v_add_f32 v33, v129, v133
v_cvt_pk_bf16_f32 v62, v126, v127
v_cvt_pk_bf16_f32 v63, v128, v129
v_cvt_pk_bf16_f32 v64, v130, v131
v_cvt_pk_bf16_f32 v65, v132, v133
buffer_load_dwordx4 v3, s[36:39], s93 offen offset:2048 nt lds
v_sub_f32 v134, v134, v26
v_sub_f32 v135, v135, v26
v_sub_f32 v136, v136, v26
v_sub_f32 v137, v137, v26
v_sub_f32 v138, v138, v26
v_sub_f32 v139, v139, v26
v_sub_f32 v140, v140, v26
v_sub_f32 v141, v141, v26
v_exp_f32 v134, v134
v_exp_f32 v135, v135
v_exp_f32 v136, v136
v_exp_f32 v137, v137
v_exp_f32 v138, v138
v_exp_f32 v139, v139
v_exp_f32 v140, v140
v_exp_f32 v141, v141
v_add_f32 v30, v30, v134
v_add_f32 v31, v31, v135
v_add_f32 v32, v32, v136
v_add_f32 v33, v33, v137
v_add_f32 v30, v30, v138
v_add_f32 v31, v31, v139
v_add_f32 v32, v32, v140
v_add_f32 v33, v33, v141
v_cvt_pk_bf16_f32 v66, v134, v135
v_cvt_pk_bf16_f32 v67, v136, v137
v_cvt_pk_bf16_f32 v68, v138, v139
v_cvt_pk_bf16_f32 v69, v140, v141
buffer_load_dwordx4 v4, s[36:39], s93 offen offset:3072 nt lds
v_sub_f32 v142, v142, v26
v_sub_f32 v143, v143, v26
v_sub_f32 v144, v144, v26
v_sub_f32 v145, v145, v26
v_sub_f32 v146, v146, v26
v_sub_f32 v147, v147, v26
v_sub_f32 v148, v148, v26
v_sub_f32 v149, v149, v26
v_exp_f32 v142, v142
v_exp_f32 v143, v143
v_exp_f32 v144, v144
v_exp_f32 v145, v145
v_exp_f32 v146, v146
v_exp_f32 v147, v147
v_exp_f32 v148, v148
v_exp_f32 v149, v149
v_add_f32 v30, v30, v142
v_add_f32 v31, v31, v143
v_add_f32 v32, v32, v144
v_add_f32 v33, v33, v145
v_add_f32 v30, v30, v146
v_add_f32 v31, v31, v147
v_add_f32 v32, v32, v148
v_add_f32 v33, v33, v149
v_cvt_pk_bf16_f32 v70, v142, v143
v_cvt_pk_bf16_f32 v71, v144, v145
v_cvt_pk_bf16_f32 v72, v146, v147
v_cvt_pk_bf16_f32 v73, v148, v149
s_add_u32 m0, s60, 8192
s_add_u32 s93, s82, 65536
buffer_load_dwordx4 v1, s[36:39], s93 offen offset:0 nt lds
v_sub_f32 v150, v150, v26
v_sub_f32 v151, v151, v26
v_sub_f32 v152, v152, v26
v_sub_f32 v153, v153, v26
v_sub_f32 v154, v154, v26
v_sub_f32 v155, v155, v26
v_sub_f32 v156, v156, v26
v_sub_f32 v157, v157, v26
v_exp_f32 v150, v150
v_exp_f32 v151, v151
v_exp_f32 v152, v152
v_exp_f32 v153, v153
v_exp_f32 v154, v154
v_exp_f32 v155, v155
v_exp_f32 v156, v156
v_exp_f32 v157, v157
v_add_f32 v30, v30, v150
v_add_f32 v31, v31, v151
v_add_f32 v32, v32, v152
v_add_f32 v33, v33, v153
v_add_f32 v30, v30, v154
v_add_f32 v31, v31, v155
v_add_f32 v32, v32, v156
v_add_f32 v33, v33, v157
v_cvt_pk_bf16_f32 v74, v150, v151
v_cvt_pk_bf16_f32 v75, v152, v153
v_cvt_pk_bf16_f32 v76, v154, v155
v_cvt_pk_bf16_f32 v77, v156, v157
buffer_load_dwordx4 v2, s[36:39], s93 offen offset:1024 nt lds
v_sub_f32 v158, v158, v26
v_sub_f32 v159, v159, v26
v_sub_f32 v160, v160, v26
v_sub_f32 v161, v161, v26
v_sub_f32 v162, v162, v26
v_sub_f32 v163, v163, v26
v_sub_f32 v164, v164, v26
v_sub_f32 v165, v165, v26
v_exp_f32 v158, v158
v_exp_f32 v159, v159
v_exp_f32 v160, v160
v_exp_f32 v161, v161
v_exp_f32 v162, v162
v_exp_f32 v163, v163
v_exp_f32 v164, v164
v_exp_f32 v165, v165
v_add_f32 v30, v30, v158
v_add_f32 v31, v31, v159
v_add_f32 v32, v32, v160
v_add_f32 v33, v33, v161
v_add_f32 v30, v30, v162
v_add_f32 v31, v31, v163
v_add_f32 v32, v32, v164
v_add_f32 v33, v33, v165
v_cvt_pk_bf16_f32 v78, v158, v159
v_cvt_pk_bf16_f32 v79, v160, v161
v_cvt_pk_bf16_f32 v80, v162, v163
v_cvt_pk_bf16_f32 v81, v164, v165
buffer_load_dwordx4 v3, s[36:39], s93 offen offset:2048 nt lds
v_sub_f32 v166, v166, v26
v_sub_f32 v167, v167, v26
v_sub_f32 v168, v168, v26
v_sub_f32 v169, v169, v26
v_sub_f32 v170, v170, v26
v_sub_f32 v171, v171, v26
v_sub_f32 v172, v172, v26
v_sub_f32 v173, v173, v26
v_exp_f32 v166, v166
v_exp_f32 v167, v167
v_exp_f32 v168, v168
v_exp_f32 v169, v169
v_exp_f32 v170, v170
v_exp_f32 v171, v171
v_exp_f32 v172, v172
v_exp_f32 v173, v173
v_add_f32 v30, v30, v166
v_add_f32 v31, v31, v167
v_add_f32 v32, v32, v168
v_add_f32 v33, v33, v169
v_add_f32 v30, v30, v170
v_add_f32 v31, v31, v171
v_add_f32 v32, v32, v172
v_add_f32 v33, v33, v173
v_cvt_pk_bf16_f32 v82, v166, v167
v_cvt_pk_bf16_f32 v83, v168, v169
v_cvt_pk_bf16_f32 v84, v170, v171
v_cvt_pk_bf16_f32 v85, v172, v173
buffer_load_dwordx4 v4, s[36:39], s93 offen offset:3072 nt lds
v_sub_f32 v174, v174, v26
v_sub_f32 v175, v175, v26
v_sub_f32 v176, v176, v26
v_sub_f32 v177, v177, v26
v_sub_f32 v178, v178, v26
v_sub_f32 v179, v179, v26
v_sub_f32 v180, v180, v26
v_sub_f32 v181, v181, v26
v_exp_f32 v174, v174
v_exp_f32 v175, v175
v_exp_f32 v176, v176
v_exp_f32 v177, v177
v_exp_f32 v178, v178
v_exp_f32 v179, v179
v_exp_f32 v180, v180
v_exp_f32 v181, v181
v_add_f32 v30, v30, v174
v_add_f32 v31, v31, v175
v_add_f32 v32, v32, v176
v_add_f32 v33, v33, v177
v_add_f32 v30, v30, v178
v_add_f32 v31, v31, v179
v_add_f32 v32, v32, v180
v_add_f32 v33, v33, v181
v_cvt_pk_bf16_f32 v86, v174, v175
v_cvt_pk_bf16_f32 v87, v176, v177
v_cvt_pk_bf16_f32 v88, v178, v179
v_cvt_pk_bf16_f32 v89, v180, v181
s_add_u32 m0, s60, 12288
s_add_u32 s93, s82, 65664
buffer_load_dwordx4 v1, s[36:39], s93 offen offset:0 nt lds
v_sub_f32 v182, v182, v26
v_sub_f32 v183, v183, v26
v_sub_f32 v184, v184, v26
v_sub_f32 v185, v185, v26
v_sub_f32 v186, v186, v26
v_sub_f32 v187, v187, v26
v_sub_f32 v188, v188, v26
v_sub_f32 v189, v189, v26
v_exp_f32 v182, v182
v_exp_f32 v183, v183
v_exp_f32 v184, v184
v_exp_f32 v185, v185
v_exp_f32 v186, v186
v_exp_f32 v187, v187
v_exp_f32 v188, v188
v_exp_f32 v189, v189
v_add_f32 v30, v30, v182
v_add_f32 v31, v31, v183
v_add_f32 v32, v32, v184
v_add_f32 v33, v33, v185
v_add_f32 v30, v30, v186
v_add_f32 v31, v31, v187
v_add_f32 v32, v32, v188
v_add_f32 v33, v33, v189
v_cvt_pk_bf16_f32 v90, v182, v183
v_cvt_pk_bf16_f32 v91, v184, v185
v_cvt_pk_bf16_f32 v92, v186, v187
v_cvt_pk_bf16_f32 v93, v188, v189
buffer_load_dwordx4 v2, s[36:39], s93 offen offset:1024 nt lds
v_add_f32 v30, v30, v31
v_add_f32 v32, v32, v33
v_add_f32 v28, v30, v32
v_mov_b32 v30, v28
s_nop 1
v_permlane32_swap_b32 v28, v30
v_add_f32 v28, v28, v30
ds_write_b32 v254, v28 offset:1024
s_waitcnt lgkmcnt(0)
s_waitcnt vmcnt(4)
buffer_load_dwordx4 v3, s[36:39], s93 offen offset:2048 nt lds
ds_read_b64_tr_b16 v[30:31], v17 offset:0
ds_read_b64_tr_b16 v[32:33], v18 offset:0
ds_read_b64_tr_b16 v[34:35], v19 offset:0
ds_read_b64_tr_b16 v[36:37], v20 offset:0
ds_read_b64_tr_b16 v[38:39], v17 offset:2048
ds_read_b64_tr_b16 v[40:41], v18 offset:2048
ds_read_b64_tr_b16 v[42:43], v19 offset:2048
ds_read_b64_tr_b16 v[44:45], v20 offset:2048
s_waitcnt lgkmcnt(6)
v_mfma_f32_32x32x16_bf16 v[126:141], v[30:33], v[62:65], 0
s_waitcnt lgkmcnt(4)
v_mfma_f32_32x32x16_bf16 v[142:157], v[34:37], v[62:65], 0
s_waitcnt lgkmcnt(2)
v_mfma_f32_32x32x16_bf16 v[126:141], v[38:41], v[66:69], v[126:141]
s_waitcnt lgkmcnt(0)
v_mfma_f32_32x32x16_bf16 v[142:157], v[42:45], v[66:69], v[142:157]
ds_read_b64_tr_b16 v[46:47], v17 offset:4096
ds_read_b64_tr_b16 v[48:49], v18 offset:4096
ds_read_b64_tr_b16 v[50:51], v19 offset:4096
ds_read_b64_tr_b16 v[52:53], v20 offset:4096
ds_read_b64_tr_b16 v[54:55], v17 offset:6144
ds_read_b64_tr_b16 v[56:57], v18 offset:6144
ds_read_b64_tr_b16 v[58:59], v19 offset:6144
ds_read_b64_tr_b16 v[60:61], v20 offset:6144
s_waitcnt lgkmcnt(6)
v_mfma_f32_32x32x16_bf16 v[158:173], v[46:49], v[62:65], 0
s_waitcnt lgkmcnt(4)
v_mfma_f32_32x32x16_bf16 v[174:189], v[50:53], v[62:65], 0
s_waitcnt lgkmcnt(2)
v_mfma_f32_32x32x16_bf16 v[158:173], v[54:57], v[66:69], v[158:173]
s_waitcnt lgkmcnt(0)
v_mfma_f32_32x32x16_bf16 v[174:189], v[58:61], v[66:69], v[174:189]
s_waitcnt vmcnt(4)
buffer_load_dwordx4 v4, s[36:39], s93 offen offset:3072 nt lds
s_add_u32 m0, s60, 0
s_add_u32 s93, s82, 131072
s_waitcnt vmcnt(4)
buffer_load_dwordx4 v1, s[36:39], s93 offen offset:0 nt lds
ds_read_b64_tr_b16 v[30:31], v17 offset:8192
ds_read_b64_tr_b16 v[32:33], v18 offset:8192
ds_read_b64_tr_b16 v[34:35], v19 offset:8192
ds_read_b64_tr_b16 v[36:37], v20 offset:8192
ds_read_b64_tr_b16 v[38:39], v17 offset:10240
ds_read_b64_tr_b16 v[40:41], v18 offset:10240
ds_read_b64_tr_b16 v[42:43], v19 offset:10240
ds_read_b64_tr_b16 v[44:45], v20 offset:10240
s_waitcnt lgkmcnt(6)
v_mfma_f32_32x32x16_bf16 v[126:141], v[30:33], v[70:73], v[126:141]
s_waitcnt lgkmcnt(4)
v_mfma_f32_32x32x16_bf16 v[142:157], v[34:37], v[70:73], v[142:157]
s_waitcnt lgkmcnt(2)
v_mfma_f32_32x32x16_bf16 v[126:141], v[38:41], v[74:77], v[126:141]
s_waitcnt lgkmcnt(0)
v_mfma_f32_32x32x16_bf16 v[142:157], v[42:45], v[74:77], v[142:157]
s_waitcnt vmcnt(4)
buffer_load_dwordx4 v2, s[36:39], s93 offen offset:1024 nt lds
s_waitcnt vmcnt(4)
buffer_load_dwordx4 v3, s[36:39], s93 offen offset:2048 nt lds
s_waitcnt vmcnt(4)
buffer_load_dwordx4 v4, s[36:39], s93 offen offset:3072 nt lds
s_add_u32 m0, s60, 4096
s_add_u32 s93, s82, 131200
s_waitcnt vmcnt(4)
buffer_load_dwordx4 v1, s[36:39], s93 offen offset:0 nt lds
ds_read_b64_tr_b16 v[46:47], v17 offset:12288
ds_read_b64_tr_b16 v[48:49], v18 offset:12288
ds_read_b64_tr_b16 v[50:51], v19 offset:12288
ds_read_b64_tr_b16 v[52:53], v20 offset:12288
ds_read_b64_tr_b16 v[54:55], v17 offset:14336
ds_read_b64_tr_b16 v[56:57], v18 offset:14336
ds_read_b64_tr_b16 v[58:59], v19 offset:14336
ds_read_b64_tr_b16 v[60:61], v20 offset:14336
s_waitcnt lgkmcnt(6)
v_mfma_f32_32x32x16_bf16 v[158:173], v[46:49], v[70:73], v[158:173]
s_waitcnt lgkmcnt(4)
v_mfma_f32_32x32x16_bf16 v[174:189], v[50:53], v[70:73], v[174:189]
s_waitcnt lgkmcnt(2)
v_mfma_f32_32x32x16_bf16 v[158:173], v[54:57], v[74:77], v[158:173]
s_waitcnt lgkmcnt(0)
v_mfma_f32_32x32x16_bf16 v[174:189], v[58:61], v[74:77], v[174:189]
s_waitcnt vmcnt(4)
buffer_load_dwordx4 v2, s[36:39], s93 offen offset:1024 nt lds
s_waitcnt vmcnt(4)
buffer_load_dwordx4 v3, s[36:39], s93 offen offset:2048 nt lds
s_waitcnt vmcnt(4)
buffer_load_dwordx4 v4, s[36:39], s93 offen offset:3072 nt lds
s_add_u32 m0, s60, 8192
s_add_u32 s93, s82, 196608
s_waitcnt vmcnt(4)
buffer_load_dwordx4 v1, s[36:39], s93 offen offset:0 nt lds
ds_read_b64_tr_b16 v[30:31], v17 offset:0
ds_read_b64_tr_b16 v[32:33], v18 offset:0
ds_read_b64_tr_b16 v[34:35], v19 offset:0
ds_read_b64_tr_b16 v[36:37], v20 offset:0
ds_read_b64_tr_b16 v[38:39], v17 offset:2048
ds_read_b64_tr_b16 v[40:41], v18 offset:2048
ds_read_b64_tr_b16 v[42:43], v19 offset:2048
ds_read_b64_tr_b16 v[44:45], v20 offset:2048
s_waitcnt lgkmcnt(6)
v_mfma_f32_32x32x16_bf16 v[126:141], v[30:33], v[78:81], v[126:141]
s_waitcnt lgkmcnt(4)
v_mfma_f32_32x32x16_bf16 v[142:157], v[34:37], v[78:81], v[142:157]
s_waitcnt lgkmcnt(2)
v_mfma_f32_32x32x16_bf16 v[126:141], v[38:41], v[82:85], v[126:141]
s_waitcnt lgkmcnt(0)
v_mfma_f32_32x32x16_bf16 v[142:157], v[42:45], v[82:85], v[142:157]
s_waitcnt vmcnt(4)
buffer_load_dwordx4 v2, s[36:39], s93 offen offset:1024 nt lds
s_waitcnt vmcnt(4)
buffer_load_dwordx4 v3, s[36:39], s93 offen offset:2048 nt lds
s_waitcnt vmcnt(4)
buffer_load_dwordx4 v4, s[36:39], s93 offen offset:3072 nt lds
s_add_u32 m0, s60, 12288
s_add_u32 s93, s82, 196736
s_waitcnt vmcnt(4)
buffer_load_dwordx4 v1, s[36:39], s93 offen offset:0 nt lds
ds_read_b64_tr_b16 v[46:47], v17 offset:4096
ds_read_b64_tr_b16 v[48:49], v18 offset:4096
ds_read_b64_tr_b16 v[50:51], v19 offset:4096
ds_read_b64_tr_b16 v[52:53], v20 offset:4096
ds_read_b64_tr_b16 v[54:55], v17 offset:6144
ds_read_b64_tr_b16 v[56:57], v18 offset:6144
ds_read_b64_tr_b16 v[58:59], v19 offset:6144
ds_read_b64_tr_b16 v[60:61], v20 offset:6144
s_waitcnt lgkmcnt(6)
v_mfma_f32_32x32x16_bf16 v[158:173], v[46:49], v[78:81], v[158:173]
s_waitcnt lgkmcnt(4)
v_mfma_f32_32x32x16_bf16 v[174:189], v[50:53], v[78:81], v[174:189]
s_waitcnt lgkmcnt(2)
v_mfma_f32_32x32x16_bf16 v[158:173], v[54:57], v[82:85], v[158:173]
s_waitcnt lgkmcnt(0)
v_mfma_f32_32x32x16_bf16 v[174:189], v[58:61], v[82:85], v[174:189]
s_waitcnt vmcnt(4)
buffer_load_dwordx4 v2, s[36:39], s93 offen offset:1024 nt lds
s_waitcnt vmcnt(4)
buffer_load_dwordx4 v3, s[36:39], s93 offen offset:2048 nt lds
s_waitcnt vmcnt(4)
buffer_load_dwordx4 v4, s[36:39], s93 offen offset:3072 nt lds
s_waitcnt vmcnt(4)
ds_read_b64_tr_b16 v[30:31], v17 offset:8192
ds_read_b64_tr_b16 v[32:33], v18 offset:8192
ds_read_b64_tr_b16 v[34:35], v19 offset:8192
ds_read_b64_tr_b16 v[36:37], v20 offset:8192
ds_read_b64_tr_b16 v[38:39], v17 offset:10240
ds_read_b64_tr_b16 v[40:41], v18 offset:10240
ds_read_b64_tr_b16 v[42:43], v19 offset:10240
ds_read_b64_tr_b16 v[44:45], v20 offset:10240
s_waitcnt lgkmcnt(6)
v_mfma_f32_32x32x16_bf16 v[126:141], v[30:33], v[86:89], v[126:141]
s_waitcnt lgkmcnt(4)
v_mfma_f32_32x32x16_bf16 v[142:157], v[34:37], v[86:89], v[142:157]
s_waitcnt lgkmcnt(2)
v_mfma_f32_32x32x16_bf16 v[126:141], v[38:41], v[90:93], v[126:141]
s_waitcnt lgkmcnt(0)
v_mfma_f32_32x32x16_bf16 v[142:157], v[42:45], v[90:93], v[142:157]
v_add_u32 v226, s60, v25
s_lshl_b32 s61, s3, 10
v_add_u32 v227, s61, v25
v_add_u32 v228, 0x10000, v227
v_and_b32 v229, 31, v0
v_lshlrev_b32 v229, 5, v229
v_add_u32 v229, 148480, v229
v_bfe_u32 v254, v0, 2, 1
v_lshrrev_b32 v255, 5, v0
v_xor_b32 v254, v254, v255
v_bfe_u32 v255, v0, 4, 1
v_or_b32 v254, v254, v255
v_lshlrev_b32 v254, 2, v254
v_bfe_u32 v255, v0, 3, 1
v_lshl_add_u32 v254, v255, 1, v254
v_bfe_u32 v255, v0, 1, 1
v_add_u32 v254, v254, v255
v_and_b32 v255, 1, v0
v_lshlrev_b32 v255, 4, v255
v_mov_b32 v222, 0x3f80
v_lshlrev_b32 v255, v255, v222
v_cmp_eq_u32 vcc, 0, v254
s_nop 1
v_cndmask_b32 v222, 0, v255, vcc
v_cmp_eq_u32 vcc, 1, v254
s_nop 1
v_cndmask_b32 v223, 0, v255, vcc
v_cmp_eq_u32 vcc, 2, v254
s_nop 1
v_cndmask_b32 v224, 0, v255, vcc
v_cmp_eq_u32 vcc, 3, v254
s_nop 1
v_cndmask_b32 v225, 0, v255, vcc
v_cvt_pk_bf16_f32 v94, v126, v127
v_cvt_pk_bf16_f32 v95, v128, v129
v_cvt_pk_bf16_f32 v96, v130, v131
v_cvt_pk_bf16_f32 v97, v132, v133
v_cvt_pk_bf16_f32 v98, v134, v135
v_cvt_pk_bf16_f32 v99, v136, v137
v_cvt_pk_bf16_f32 v100, v138, v139
v_cvt_pk_bf16_f32 v101, v140, v141
v_cvt_pk_bf16_f32 v102, v142, v143
v_cvt_pk_bf16_f32 v103, v144, v145
v_cvt_pk_bf16_f32 v104, v146, v147
v_cvt_pk_bf16_f32 v105, v148, v149
v_cvt_pk_bf16_f32 v106, v150, v151
v_cvt_pk_bf16_f32 v107, v152, v153
v_cvt_pk_bf16_f32 v108, v154, v155
v_cvt_pk_bf16_f32 v109, v156, v157
ds_write_b128 v226, v[94:97] offset:8192
ds_write_b128 v226, v[98:101] offset:9216
ds_write_b128 v226, v[102:105] offset:10240
ds_write_b128 v226, v[106:109] offset:11264
s_waitcnt lgkmcnt(0)
s_waitcnt vmcnt(0)
ds_read_b64_tr_b16 v[46:47], v17 offset:12288
ds_read_b64_tr_b16 v[48:49], v18 offset:12288
ds_read_b64_tr_b16 v[50:51], v19 offset:12288
ds_read_b64_tr_b16 v[52:53], v20 offset:12288
ds_read_b64_tr_b16 v[54:55], v17 offset:14336
ds_read_b64_tr_b16 v[56:57], v18 offset:14336
ds_read_b64_tr_b16 v[58:59], v19 offset:14336
ds_read_b64_tr_b16 v[60:61], v20 offset:14336
s_waitcnt lgkmcnt(6)
v_mfma_f32_32x32x16_bf16 v[158:173], v[46:49], v[86:89], v[158:173]
s_waitcnt lgkmcnt(4)
v_mfma_f32_32x32x16_bf16 v[174:189], v[50:53], v[86:89], v[174:189]
s_waitcnt lgkmcnt(2)
v_mfma_f32_32x32x16_bf16 v[158:173], v[54:57], v[90:93], v[158:173]
s_waitcnt lgkmcnt(0)
v_mfma_f32_32x32x16_bf16 v[174:189], v[58:61], v[90:93], v[174:189]
s_nop 9
v_cvt_pk_bf16_f32 v110, v158, v159
v_cvt_pk_bf16_f32 v111, v160, v161
v_cvt_pk_bf16_f32 v112, v162, v163
v_cvt_pk_bf16_f32 v113, v164, v165
v_cvt_pk_bf16_f32 v114, v166, v167
v_cvt_pk_bf16_f32 v115, v168, v169
v_cvt_pk_bf16_f32 v116, v170, v171
v_cvt_pk_bf16_f32 v117, v172, v173
v_cvt_pk_bf16_f32 v118, v174, v175
v_cvt_pk_bf16_f32 v119, v176, v177
v_cvt_pk_bf16_f32 v120, v178, v179
v_cvt_pk_bf16_f32 v121, v180, v181
v_cvt_pk_bf16_f32 v122, v182, v183
v_cvt_pk_bf16_f32 v123, v184, v185
v_cvt_pk_bf16_f32 v124, v186, v187
v_cvt_pk_bf16_f32 v125, v188, v189
ds_write_b128 v226, v[110:113] offset:12288
ds_write_b128 v226, v[114:117] offset:13312
ds_write_b128 v226, v[118:121] offset:14336
ds_write_b128 v226, v[122:125] offset:15360
s_waitcnt lgkmcnt(0)
s_barrier
ds_read_b128 v[174:177], v229 offset:0
ds_read_b128 v[178:181], v229 offset:16
ds_read_b128 v[126:129], v227 offset:8192
ds_read_b128 v[130:133], v227 offset:24576
ds_read_b128 v[134:137], v227 offset:40960
ds_read_b128 v[138:141], v227 offset:57344
ds_read_b128 v[142:145], v228 offset:8192
ds_read_b128 v[146:149], v228 offset:24576
ds_read_b128 v[150:153], v228 offset:40960
ds_read_b128 v[154:157], v228 offset:57344
s_waitcnt lgkmcnt(8)
v_add_f32 v174, v174, v175
v_add_f32 v176, v176, v177
v_add_f32 v178, v178, v179
v_add_f32 v180, v180, v181
v_add_f32 v174, v174, v176
v_add_f32 v178, v178, v180
v_add_f32 v174, v174, v178
v_rcp_f32 v174, v174
s_waitcnt lgkmcnt(7)
v_mfma_f32_32x32x16_bf16 v[158:173], v[222:225], v[126:129], 0
s_waitcnt lgkmcnt(6)
v_mfma_f32_32x32x16_bf16 v[158:173], v[222:225], v[130:133], v[158:173]
s_waitcnt lgkmcnt(5)
v_mfma_f32_32x32x16_bf16 v[158:173], v[222:225], v[134:137], v[158:173]
s_waitcnt lgkmcnt(4)
v_mfma_f32_32x32x16_bf16 v[158:173], v[222:225], v[138:141], v[158:173]
s_waitcnt lgkmcnt(3)
v_mfma_f32_32x32x16_bf16 v[158:173], v[222:225], v[142:145], v[158:173]
s_waitcnt lgkmcnt(2)
v_mfma_f32_32x32x16_bf16 v[158:173], v[222:225], v[146:149], v[158:173]
s_waitcnt lgkmcnt(1)
v_mfma_f32_32x32x16_bf16 v[158:173], v[222:225], v[150:153], v[158:173]
s_waitcnt lgkmcnt(0)
v_mfma_f32_32x32x16_bf16 v[158:173], v[222:225], v[154:157], v[158:173]
s_nop 11
v_mul_f32 v158, v174, v158
v_mul_f32 v159, v174, v159
v_mul_f32 v160, v174, v160
v_mul_f32 v161, v174, v161
v_mul_f32 v162, v174, v162
v_mul_f32 v163, v174, v163
v_mul_f32 v164, v174, v164
v_mul_f32 v165, v174, v165
v_cvt_pk_bf16_f32 v166, v158, v159
v_cvt_pk_bf16_f32 v167, v160, v161
v_cvt_pk_bf16_f32 v168, v162, v163
v_cvt_pk_bf16_f32 v169, v164, v165
buffer_store_dwordx4 v[166:169], v227, s[56:59], s67 offen sc1
s_waitcnt vmcnt(0)
v_mov_b32 v254, 1
s_mov_b64 exec, 1
buffer_store_dword v254, off, s[56:59], s69 offset:0 sc1
s_mov_b64 exec, -1
s_barrier
v_and_b32 v12, 0, v0
v_lshlrev_b32 v12, 2, v12
buffer_load_dword v10, v12, s[56:59], s80 offen sc1
s_waitcnt vmcnt(0)
s_mov_b32 s62, 0
s_nop 4
L_chk_12:
v_cmp_ne_u32 vcc, 1, v10
s_add_u32 s62, s62, 1
s_nop 2
s_cbranch_vccz L_ok_13
s_cmp_lt_u32 s62, 200000
s_cbranch_scc0 L_ok_13
s_sleep 4
buffer_load_dword v10, v12, s[56:59], s80 offen sc1
s_waitcnt vmcnt(0)
s_branch L_chk_12
L_ok_13:
buffer_load_dwordx4 v[94:97], v25, s[56:59], s79 offen offset:0 sc1
buffer_load_dwordx4 v[98:101], v25, s[56:59], s79 offen offset:1024 sc1
buffer_load_dwordx4 v[102:105], v25, s[56:59], s79 offen offset:2048 sc1
buffer_load_dwordx4 v[106:109], v25, s[56:59], s79 offen offset:3072 sc1
s_waitcnt vmcnt(0)
s_mov_b32 s62, 0xffff0000
v_lshlrev_b32 v62, 16, v94
v_and_b32 v63, s62, v94
v_lshlrev_b32 v64, 16, v95
v_and_b32 v65, s62, v95
v_lshlrev_b32 v66, 16, v96
v_and_b32 v67, s62, v96
v_lshlrev_b32 v68, 16, v97
v_and_b32 v69, s62, v97
v_lshlrev_b32 v70, 16, v98
v_and_b32 v71, s62, v98
v_lshlrev_b32 v72, 16, v99
v_and_b32 v73, s62, v99
v_lshlrev_b32 v74, 16, v100
v_and_b32 v75, s62, v100
v_lshlrev_b32 v76, 16, v101
v_and_b32 v77, s62, v101
v_lshlrev_b32 v78, 16, v102
v_and_b32 v79, s62, v102
v_lshlrev_b32 v80, 16, v103
v_and_b32 v81, s62, v103
v_lshlrev_b32 v82, 16, v104
v_and_b32 v83, s62, v104
v_lshlrev_b32 v84, 16, v105
v_and_b32 v85, s62, v105
v_lshlrev_b32 v86, 16, v106
v_and_b32 v87, s62, v106
v_lshlrev_b32 v88, 16, v107
v_and_b32 v89, s62, v107
v_lshlrev_b32 v90, 16, v108
v_and_b32 v91, s62, v108
v_lshlrev_b32 v92, 16, v109
v_and_b32 v93, s62, v109
v_lshrrev_b32 v255, 5, v0
v_and_b32 v38, 31, v0
v_xor_b32 v38, v38, v255
v_lshlrev_b32 v38, 4, v38
v_lshlrev_b32 v255, 9, v255
v_add3_u32 v38, v38, v255, s60
v_lshrrev_b32 v41, 4, v0
s_lshl_b32 s61, s3, 2
v_add_u32 v41, s61, v41
v_and_b32 v255, 15, v0
v_xor_b32 v39, v41, v255
v_lshlrev_b32 v39, 4, v39
v_lshl_add_u32 v39, v255, 9, v39
v_add_u32 v40, 0x10000, v39
v_lshlrev_b32 v41, 12, v41
v_lshl_add_u32 v41, v255, 3, v41
v_xor_b32 v31, 32, v38
v_xor_b32 v32, 64, v38
v_xor_b32 v33, 96, v38
v_xor_b32 v34, 128, v38
v_xor_b32 v35, 160, v38
v_xor_b32 v36, 192, v38
v_xor_b32 v37, 224, v38
ds_write_b128 v38, v[62:65] offset:0
ds_write_b128 v31, v[66:69] offset:1024
ds_write_b128 v32, v[70:73] offset:2048
ds_write_b128 v33, v[74:77] offset:3072
ds_write_b128 v34, v[78:81] offset:4096
ds_write_b128 v35, v[82:85] offset:5120
ds_write_b128 v36, v[86:89] offset:6144
ds_write_b128 v37, v[90:93] offset:7168
s_waitcnt lgkmcnt(0)
s_barrier
ds_read_b128 v[126:129], v39 offset:0
ds_read_b128 v[130:133], v39 offset:16384
ds_read_b128 v[134:137], v39 offset:32768
ds_read_b128 v[138:141], v39 offset:49152
ds_read_b128 v[142:145], v40 offset:0
ds_read_b128 v[146:149], v40 offset:16384
ds_read_b128 v[150:153], v40 offset:32768
ds_read_b128 v[154:157], v40 offset:49152
s_waitcnt lgkmcnt(6)
v_add_f32 v126, v126, v130
v_add_f32 v127, v127, v131
v_add_f32 v128, v128, v132
v_add_f32 v129, v129, v133
s_waitcnt lgkmcnt(5)
v_add_f32 v126, v126, v134
v_add_f32 v127, v127, v135
v_add_f32 v128, v128, v136
v_add_f32 v129, v129, v137
s_waitcnt lgkmcnt(4)
v_add_f32 v126, v126, v138
v_add_f32 v127, v127, v139
v_add_f32 v128, v128, v140
v_add_f32 v129, v129, v141
s_waitcnt lgkmcnt(3)
v_add_f32 v126, v126, v142
v_add_f32 v127, v127, v143
v_add_f32 v128, v128, v144
v_add_f32 v129, v129, v145
s_waitcnt lgkmcnt(2)
v_add_f32 v126, v126, v146
v_add_f32 v127, v127, v147
v_add_f32 v128, v128, v148
v_add_f32 v129, v129, v149
s_waitcnt lgkmcnt(1)
v_add_f32 v126, v126, v150
v_add_f32 v127, v127, v151
v_add_f32 v128, v128, v152
v_add_f32 v129, v129, v153
s_waitcnt lgkmcnt(0)
v_add_f32 v126, v126, v154
v_add_f32 v127, v127, v155
v_add_f32 v128, v128, v156
v_add_f32 v129, v129, v157
v_cvt_pk_bf16_f32 v130, v126, v127
v_cvt_pk_bf16_f32 v131, v128, v129
buffer_store_dwordx2 v[130:131], v41, s[48:51], s77 offen
s_endpgm
L_late_6:
buffer_load_dword v10, v12, s[56:59], s72 offen sc1
s_add_u32 m0, s60, 12288
s_add_u32 s93, s81, 65664
s_waitcnt vmcnt(3)
buffer_load_dwordx4 v1, s[36:39], s93 offen offset:0 nt lds
s_waitcnt vmcnt(3)
buffer_load_dwordx4 v2, s[36:39], s93 offen offset:1024 nt lds
s_waitcnt vmcnt(3)
buffer_load_dwordx4 v3, s[36:39], s93 offen offset:2048 nt lds
s_waitcnt vmcnt(3)
buffer_load_dwordx4 v4, s[36:39], s93 offen offset:3072 nt lds
s_mov_b32 s62, 0
L_chk_8:
v_cmp_ne_u32 vcc, 1, v10
s_add_u32 s62, s62, 1
s_nop 2
s_cbranch_vccz L_ok_9
s_cmp_lt_u32 s62, 200000
s_cbranch_scc0 L_ok_9
s_sleep 4
buffer_load_dword v10, v12, s[56:59], s72 offen sc1
s_waitcnt vmcnt(0)
s_branch L_chk_8
L_ok_9:
s_lshl_b32 s61, s3, 10
s_add_u32 s62, s61, 131072
s_add_u32 s61, s61, s71
s_mov_b32 s63, m0
s_mov_b32 m0, s62
s_nop 0
buffer_load_dwordx4 v25, s[56:59], s61 offen offset:0 sc1 lds
s_mov_b32 m0, s63
s_waitcnt vmcnt(0)
s_branch L_join_7
L_roleG:
s_nop 1
s_lshr_b32 s64, s4, 2
s_xor_b32 s64, s64, 1
s_and_b32 s61, s5, 7
s_and_b32 s65, s4, 3
s_lshl_b32 s65, s65, 3
s_add_u32 s65, s65, s61
s_lshr_b32 s66, s5, 3
s_lshl_b32 s78, s61, 1
s_lshl_b32 s61, s66, 3
s_add_u32 s78, s78, s61
s_and_b32 s61, s4, 1
s_add_u32 s78, s78, s61
s_lshl_b32 s61, s66, 2
s_add_u32 s61, s61, s3
s_lshl_b32 s61, s61, 16
s_bfe_u32 s62, s3, 0x10001
s_lshl_b32 s62, s62, 18
s_and_b32 s63, s3, 1
s_lshl_b32 s63, s63, 7
s_add_u32 s62, s62, s63
s_lshl_b32 s63, s65, 8
s_add_u32 s62, s62, s63
s_cmp_lt_u32 s3, 4
s_cselect_b32 s76, s61, s62
s_cselect_b32 s77, 7, 19
s_cselect_b64 vcc, -1, 0
v_cndmask_b32 v222, v9, v5, vcc
v_cndmask_b32 v223, v10, v6, vcc
v_cndmask_b32 v224, v11, v7, vcc
v_cndmask_b32 v225, v12, v8, vcc
s_cselect_b32 s98, 0x80000, s42
s_mov_b32 s99, 0x20000
s_waitcnt lgkmcnt(0)
s_cmp_eq_u32 s64, 0
s_cselect_b32 s61, s8, s18
s_cselect_b32 s62, s14, s24
s_cmp_lt_u32 s3, 4
s_cselect_b32 s96, s61, s62
s_cmp_eq_u32 s64, 0
s_cselect_b32 s61, s9, s19
s_cselect_b32 s62, s15, s25
s_cmp_lt_u32 s3, 4
s_cselect_b32 s97, s61, s62
s_add_u32 m0, s60, 0
s_add_u32 s93, s78, 0
s_and_b32 s93, s93, 15
s_lshl_b32 s93, s93, s77
s_add_u32 s93, s93, s76
buffer_load_dwordx4 v222, s[96:99], s93 offen offset:0  lds
buffer_load_dwordx4 v223, s[96:99], s93 offen offset:1024  lds
buffer_load_dwordx4 v224, s[96:99], s93 offen offset:2048  lds
buffer_load_dwordx4 v225, s[96:99], s93 offen offset:3072  lds
s_barrier
s_add_u32 m0, s60, 4096
s_add_u32 s93, s78, 1
s_and_b32 s93, s93, 15
s_lshl_b32 s93, s93, s77
s_add_u32 s93, s93, s76
buffer_load_dwordx4 v222, s[96:99], s93 offen offset:0  lds
buffer_load_dwordx4 v223, s[96:99], s93 offen offset:1024  lds
buffer_load_dwordx4 v224, s[96:99], s93 offen offset:2048  lds
buffer_load_dwordx4 v225, s[96:99], s93 offen offset:3072  lds
s_barrier
s_add_u32 m0, s60, 8192
s_add_u32 s93, s78, 2
s_and_b32 s93, s93, 15
s_lshl_b32 s93, s93, s77
s_add_u32 s93, s93, s76
buffer_load_dwordx4 v222, s[96:99], s93 offen offset:0  lds
buffer_load_dwordx4 v223, s[96:99], s93 offen offset:1024  lds
buffer_load_dwordx4 v224, s[96:99], s93 offen offset:2048  lds
buffer_load_dwordx4 v225, s[96:99], s93 offen offset:3072  lds
s_mov_b32 s57, s33
s_mov_b32 s56, s32
s_mov_b32 s53, s31
s_mov_b32 s52, s30
s_mov_b32 s49, s29
s_mov_b32 s48, s28
s_mov_b32 s45, s27
s_mov_b32 s44, s26
s_mov_b32 s41, s25
s_mov_b32 s40, s24
s_mov_b32 s37, s23
s_mov_b32 s36, s22
s_mov_b32 s33, s21
s_mov_b32 s32, s20
s_mov_b32 s29, s19
s_mov_b32 s28, s18
s_mov_b32 s30, 0x80000
s_mov_b32 s31, 0x20000
s_mov_b32 s25, s17
s_mov_b32 s24, s16
s_mov_b32 s26, 0x800000
s_mov_b32 s27, 0x20000
s_mov_b32 s21, s15
s_mov_b32 s20, s14
s_mov_b32 s22, 0x800000
s_mov_b32 s23, 0x20000
s_mov_b32 s17, s13
s_mov_b32 s16, s12
s_mov_b32 s18, 0x800000
s_mov_b32 s19, 0x20000
s_mov_b32 s13, s11
s_mov_b32 s12, s10
s_mov_b32 s14, 0x800000
s_mov_b32 s15, 0x20000
s_mov_b32 s10, 0x80000
s_mov_b32 s11, 0x20000
s_and_b32 s63, s4, 1
s_lshl_b32 s67, s63, 2
s_lshr_b32 s61, s5, 2
s_add_u32 s67, s67, s61
s_and_b32 s69, s5, 3
s_lshr_b32 s62, s4, 1
s_lshl_b32 s68, s62, 3
s_lshl_b32 s61, s69, 1
s_add_u32 s68, s68, s61
s_lshl_b32 s70, s67, 2
s_add_u32 s70, s70, s62
s_and_b32 s75, s5, 7
s_lshl_b32 s72, s67, 12
s_lshl_b32 s61, s68, 7
s_add_u32 s72, s72, s61
s_add_u32 s72, s72, 10485760
s_lshl_b32 s80, s64, 3
s_lshl_b32 s61, s66, 2
s_add_u32 s80, s80, s61
s_lshl_b32 s74, s80, 12
s_lshl_b32 s61, s65, 7
s_add_u32 s74, s74, s61
s_add_u32 s74, s74, 10551296
s_lshl_b32 s80, s66, 13
s_lshl_b32 s61, s75, 8
s_add_u32 s80, s80, s61
s_lshl_b32 s61, s4, 2
s_add_u32 s80, s80, s61
s_add_u32 s80, s80, 10616832
s_and_b32 s81, s2, 127
s_lshl_b32 s81, s81, 7
s_add_u32 s81, s81, 10633216
s_cmp_lg_u32 s3, 0
s_cbranch_scc1 L_clr_14
v_mov_b32 v255, 0
v_lshrrev_b32 v254, 3, v0
v_lshlrev_b32 v254, 7, v254
v_and_b32 v30, 7, v0
v_lshl_add_u32 v254, v30, 2, v254
s_mov_b64 exec, 0xffff
buffer_store_dword v255, v254, s[56:59], s72 offen sc1
s_mov_b64 exec, -1
v_lshrrev_b32 v254, 1, v0
v_lshlrev_b32 v254, 12, v254
v_and_b32 v30, 1, v0
v_lshl_add_u32 v254, v30, 2, v254
s_mov_b64 exec, 0xff
buffer_store_dword v255, v254, s[56:59], s74 offen sc1
s_mov_b64 exec, -1
v_bfe_u32 v30, v0, 1, 2
v_lshlrev_b32 v254, 11, v30
v_and_b32 v30, 1, v0
v_lshl_add_u32 v254, v30, 7, v254
s_mov_b64 exec, 0xff
buffer_store_dword v255, v254, s[56:59], s80 offen sc1
s_mov_b64 exec, -1
L_clr_14:
v_bfe_u32 v30, v0, 1, 1
v_lshlrev_b32 v30, 2, v30
v_bfe_u32 v31, v0, 2, 2
v_or_b32 v30, v30, v31
v_lshrrev_b32 v31, 5, v0
v_xor_b32 v30, v30, v31
v_lshlrev_b32 v30, 4, v30
v_and_b32 v31, 31, v0
v_lshl_add_u32 v30, v31, 7, v30
v_add_u32 v13, s60, v30
v_xor_b32 v14, 32, v13
v_xor_b32 v15, 64, v13
v_xor_b32 v16, 96, v13
v_bfe_u32 v30, v0, 1, 1
v_and_b32 v31, 1, v0
v_bfe_u32 v32, v0, 4, 1
v_lshl_add_u32 v30, v32, 1, v30
v_bfe_u32 v32, v0, 3, 1
v_lshlrev_b32 v32, 2, v32
v_xor_b32 v30, v30, v32
v_lshrrev_b32 v32, 5, v0
v_xor_b32 v30, v30, v32
v_lshlrev_b32 v30, 4, v30
v_lshl_add_u32 v30, v31, 3, v30
v_bfe_u32 v31, v0, 2, 2
v_lshl_add_u32 v31, v32, 2, v31
v_lshl_add_u32 v30, v31, 7, v30
v_add_u32 v17, s60, v30
v_xor_b32 v18, 32, v17
v_add_u32 v18, 1024, v18
v_xor_b32 v19, 64, v17
v_xor_b32 v20, 64, v18
v_and_b32 v30, 1, v0
v_bfe_u32 v31, v0, 1, 1
v_bfe_u32 v32, v0, 4, 1
v_lshl_add_u32 v30, v32, 1, v30
v_bfe_u32 v32, v0, 3, 1
v_lshlrev_b32 v32, 2, v32
v_xor_b32 v30, v30, v32
v_lshrrev_b32 v32, 5, v0
v_lshlrev_b32 v33, 1, v32
v_xor_b32 v30, v30, v33
v_lshlrev_b32 v30, 4, v30
v_lshl_add_u32 v30, v31, 3, v30
v_bfe_u32 v31, v0, 2, 2
v_lshl_add_u32 v31, v32, 3, v31
v_lshl_add_u32 v30, v31, 7, v30
v_add_u32 v21, s60, v30
v_xor_b32 v22, 16, v21
v_add_u32 v22, 512, v22
v_xor_b32 v23, 64, v21
v_xor_b32 v24, 64, v22
s_and_b32 s61, s3, 3
s_lshl_b32 s61, s61, 14
s_lshr_b32 s62, s3, 2
s_add_u32 s62, s62, 4
s_lshl_b32 s62, s62, 14
s_sub_u32 s62, s62, s60
s_sub_u32 s61, s61, s60
v_add_u32 v226, s61, v13
v_add_u32 v227, s61, v14
v_add_u32 v228, s61, v15
v_add_u32 v229, s61, v16
v_add_u32 v230, s62, v21
v_add_u32 v231, s62, v22
v_add_u32 v232, s62, v23
v_add_u32 v233, s62, v24
s_lshl_b32 s71, s67, 5
s_add_u32 s71, s71, s68
s_lshl_b32 s71, s71, 13
s_lshl_b32 s61, s3, 2
s_add_u32 s72, s72, s61
s_and_b32 s61, s3, 3
s_lshr_b32 s63, s3, 2
s_lshl_b32 s62, s61, 12
s_add_u32 s74, s74, s62
s_lshl_b32 s62, s63, 2
s_add_u32 s74, s74, s62
s_lshl_b32 s73, s64, 3
s_lshl_b32 s62, s66, 2
s_add_u32 s73, s73, s62
s_add_u32 s73, s73, s61
s_lshl_b32 s73, s73, 5
s_add_u32 s73, s73, s65
s_lshl_b32 s73, s73, 1
s_add_u32 s73, s73, s63
s_lshl_b32 s73, s73, 12
s_add_u32 s73, s73, 4194304
s_mov_b32 s64, s66
s_lshl_b32 s79, s70, 18
s_lshl_b32 s61, s3, 13
s_add_u32 s79, s79, s61
s_waitcnt vmcnt(8)
s_barrier
ds_read_b128 v[126:129], v226 offset:0
ds_read_b64_tr_b16 v[142:143], v230 offset:0
ds_read_b64_tr_b16 v[144:145], v231 offset:0
ds_read_b64_tr_b16 v[146:147], v232 offset:0
ds_read_b64_tr_b16 v[148:149], v233 offset:0
ds_read_b128 v[130:133], v227 offset:0
ds_read_b64_tr_b16 v[150:151], v230 offset:2048
ds_read_b64_tr_b16 v[152:153], v231 offset:2048
ds_read_b64_tr_b16 v[154:155], v232 offset:2048
ds_read_b64_tr_b16 v[156:157], v233 offset:2048
ds_read_b128 v[134:137], v228 offset:0
ds_read_b64_tr_b16 v[158:159], v230 offset:32768
s_waitcnt lgkmcnt(4)
ds_read_b64_tr_b16 v[160:161], v231 offset:32768
ds_read_b64_tr_b16 v[162:163], v232 offset:32768
ds_read_b64_tr_b16 v[164:165], v233 offset:32768
ds_read_b128 v[138:141], v229 offset:0
ds_read_b64_tr_b16 v[166:167], v230 offset:34816
ds_read_b64_tr_b16 v[168:169], v231 offset:34816
ds_read_b64_tr_b16 v[170:171], v232 offset:34816
ds_read_b64_tr_b16 v[172:173], v233 offset:34816
s_waitcnt vmcnt(4)
s_waitcnt lgkmcnt(0)
s_barrier
v_mfma_f32_32x32x16_bf16 v[62:77], v[142:145], v[126:129], 0
s_add_u32 m0, s60, 12288
s_add_u32 s93, s78, 3
s_and_b32 s93, s93, 15
s_lshl_b32 s93, s93, s77
s_add_u32 s93, s93, s76
buffer_load_dwordx4 v222, s[96:99], s93 offen offset:0  lds
ds_read_b128 v[174:177], v226 offset:4096
ds_read_b64_tr_b16 v[190:191], v230 offset:4096
ds_read_b64_tr_b16 v[192:193], v231 offset:4096
ds_read_b64_tr_b16 v[194:195], v232 offset:4096
v_mfma_f32_32x32x16_bf16 v[78:93], v[146:149], v[126:129], 0
ds_read_b64_tr_b16 v[196:197], v233 offset:4096
buffer_load_dwordx4 v223, s[96:99], s93 offen offset:1024  lds
ds_read_b128 v[178:181], v227 offset:4096
ds_read_b64_tr_b16 v[198:199], v230 offset:6144
ds_read_b64_tr_b16 v[200:201], v231 offset:6144
v_mfma_f32_32x32x16_bf16 v[62:77], v[150:153], v[130:133], v[62:77]
ds_read_b64_tr_b16 v[202:203], v232 offset:6144
ds_read_b64_tr_b16 v[204:205], v233 offset:6144
buffer_load_dwordx4 v224, s[96:99], s93 offen offset:2048  lds
s_waitcnt lgkmcnt(5)
ds_read_b128 v[182:185], v228 offset:4096
v_mfma_f32_32x32x16_bf16 v[78:93], v[154:157], v[130:133], v[78:93]
ds_read_b64_tr_b16 v[206:207], v230 offset:36864
ds_read_b64_tr_b16 v[208:209], v231 offset:36864
ds_read_b64_tr_b16 v[210:211], v232 offset:36864
ds_read_b64_tr_b16 v[212:213], v233 offset:36864
buffer_load_dwordx4 v225, s[96:99], s93 offen offset:3072  lds
v_mfma_f32_32x32x16_bf16 v[62:77], v[158:161], v[134:137], v[62:77]
ds_read_b128 v[186:189], v229 offset:4096
ds_read_b64_tr_b16 v[214:215], v230 offset:38912
ds_read_b64_tr_b16 v[216:217], v231 offset:38912
ds_read_b64_tr_b16 v[218:219], v232 offset:38912
ds_read_b64_tr_b16 v[220:221], v233 offset:38912
v_mfma_f32_32x32x16_bf16 v[78:93], v[162:165], v[134:137], v[78:93]
v_mfma_f32_32x32x16_bf16 v[62:77], v[166:169], v[138:141], v[62:77]
v_mfma_f32_32x32x16_bf16 v[78:93], v[170:173], v[138:141], v[78:93]
s_waitcnt vmcnt(4)
s_waitcnt lgkmcnt(0)
s_barrier
v_mfma_f32_32x32x16_bf16 v[62:77], v[190:193], v[174:177], v[62:77]
s_add_u32 m0, s60, 0
s_add_u32 s93, s78, 4
s_and_b32 s93, s93, 15
s_lshl_b32 s93, s93, s77
s_add_u32 s93, s93, s76
buffer_load_dwordx4 v222, s[96:99], s93 offen offset:0  lds
ds_read_b128 v[126:129], v226 offset:8192
ds_read_b64_tr_b16 v[142:143], v230 offset:8192
ds_read_b64_tr_b16 v[144:145], v231 offset:8192
ds_read_b64_tr_b16 v[146:147], v232 offset:8192
v_mfma_f32_32x32x16_bf16 v[78:93], v[194:197], v[174:177], v[78:93]
ds_read_b64_tr_b16 v[148:149], v233 offset:8192
buffer_load_dwordx4 v223, s[96:99], s93 offen offset:1024  lds
ds_read_b128 v[130:133], v227 offset:8192
ds_read_b64_tr_b16 v[150:151], v230 offset:10240
ds_read_b64_tr_b16 v[152:153], v231 offset:10240
v_mfma_f32_32x32x16_bf16 v[62:77], v[198:201], v[178:181], v[62:77]
ds_read_b64_tr_b16 v[154:155], v232 offset:10240
ds_read_b64_tr_b16 v[156:157], v233 offset:10240
buffer_load_dwordx4 v224, s[96:99], s93 offen offset:2048  lds
s_waitcnt lgkmcnt(5)
ds_read_b128 v[134:137], v228 offset:8192
v_mfma_f32_32x32x16_bf16 v[78:93], v[202:205], v[178:181], v[78:93]
ds_read_b64_tr_b16 v[158:159], v230 offset:40960
ds_read_b64_tr_b16 v[160:161], v231 offset:40960
ds_read_b64_tr_b16 v[162:163], v232 offset:40960
ds_read_b64_tr_b16 v[164:165], v233 offset:40960
buffer_load_dwordx4 v225, s[96:99], s93 offen offset:3072  lds
v_mfma_f32_32x32x16_bf16 v[62:77], v[206:209], v[182:185], v[62:77]
ds_read_b128 v[138:141], v229 offset:8192
ds_read_b64_tr_b16 v[166:167], v230 offset:43008
ds_read_b64_tr_b16 v[168:169], v231 offset:43008
ds_read_b64_tr_b16 v[170:171], v232 offset:43008
ds_read_b64_tr_b16 v[172:173], v233 offset:43008
v_mfma_f32_32x32x16_bf16 v[78:93], v[210:213], v[182:185], v[78:93]
v_mfma_f32_32x32x16_bf16 v[62:77], v[214:217], v[186:189], v[62:77]
v_mfma_f32_32x32x16_bf16 v[78:93], v[218:221], v[186:189], v[78:93]
s_waitcnt vmcnt(4)
s_cmp_lg_u32 s3, 0
s_cbranch_scc1 L_sig_15
v_mov_b32 v255, 1
s_mov_b64 exec, 1
s_and_b32 s61, s2, 63
s_lshl_b32 s61, s61, 2
buffer_atomic_add v255, off, s[52:55], s61 sc1
s_mov_b64 exec, -1
L_sig_15:
s_waitcnt lgkmcnt(0)
s_barrier
v_mfma_f32_32x32x16_bf16 v[62:77], v[142:145], v[126:129], v[62:77]
s_add_u32 m0, s60, 4096
s_add_u32 s93, s78, 5
s_and_b32 s93, s93, 15
s_lshl_b32 s93, s93, s77
s_add_u32 s93, s93, s76
buffer_load_dwordx4 v222, s[96:99], s93 offen offset:0  lds
ds_read_b128 v[174:177], v226 offset:12288
ds_read_b64_tr_b16 v[190:191], v230 offset:12288
ds_read_b64_tr_b16 v[192:193], v231 offset:12288
ds_read_b64_tr_b16 v[194:195], v232 offset:12288
v_mfma_f32_32x32x16_bf16 v[78:93], v[146:149], v[126:129], v[78:93]
ds_read_b64_tr_b16 v[196:197], v233 offset:12288
buffer_load_dwordx4 v223, s[96:99], s93 offen offset:1024  lds
ds_read_b128 v[178:181], v227 offset:12288
ds_read_b64_tr_b16 v[198:199], v230 offset:14336
ds_read_b64_tr_b16 v[200:201], v231 offset:14336
v_mfma_f32_32x32x16_bf16 v[62:77], v[150:153], v[130:133], v[62:77]
ds_read_b64_tr_b16 v[202:203], v232 offset:14336
ds_read_b64_tr_b16 v[204:205], v233 offset:14336
buffer_load_dwordx4 v224, s[96:99], s93 offen offset:2048  lds
s_waitcnt lgkmcnt(5)
ds_read_b128 v[182:185], v228 offset:12288
v_mfma_f32_32x32x16_bf16 v[78:93], v[154:157], v[130:133], v[78:93]
ds_read_b64_tr_b16 v[206:207], v230 offset:45056
ds_read_b64_tr_b16 v[208:209], v231 offset:45056
ds_read_b64_tr_b16 v[210:211], v232 offset:45056
ds_read_b64_tr_b16 v[212:213], v233 offset:45056
buffer_load_dwordx4 v225, s[96:99], s93 offen offset:3072  lds
v_mfma_f32_32x32x16_bf16 v[62:77], v[158:161], v[134:137], v[62:77]
ds_read_b128 v[186:189], v229 offset:12288
ds_read_b64_tr_b16 v[214:215], v230 offset:47104
ds_read_b64_tr_b16 v[216:217], v231 offset:47104
ds_read_b64_tr_b16 v[218:219], v232 offset:47104
ds_read_b64_tr_b16 v[220:221], v233 offset:47104
v_mfma_f32_32x32x16_bf16 v[78:93], v[162:165], v[134:137], v[78:93]
v_mfma_f32_32x32x16_bf16 v[62:77], v[166:169], v[138:141], v[62:77]
v_mfma_f32_32x32x16_bf16 v[78:93], v[170:173], v[138:141], v[78:93]
s_waitcnt vmcnt(4)
s_waitcnt lgkmcnt(0)
s_barrier
v_mfma_f32_32x32x16_bf16 v[62:77], v[190:193], v[174:177], v[62:77]
s_add_u32 m0, s60, 8192
s_add_u32 s93, s78, 6
s_and_b32 s93, s93, 15
s_lshl_b32 s93, s93, s77
s_add_u32 s93, s93, s76
buffer_load_dwordx4 v222, s[96:99], s93 offen offset:0  lds
ds_read_b128 v[126:129], v226 offset:0
ds_read_b64_tr_b16 v[142:143], v230 offset:0
ds_read_b64_tr_b16 v[144:145], v231 offset:0
ds_read_b64_tr_b16 v[146:147], v232 offset:0
v_mfma_f32_32x32x16_bf16 v[78:93], v[194:197], v[174:177], v[78:93]
ds_read_b64_tr_b16 v[148:149], v233 offset:0
buffer_load_dwordx4 v223, s[96:99], s93 offen offset:1024  lds
ds_read_b128 v[130:133], v227 offset:0
ds_read_b64_tr_b16 v[150:151], v230 offset:2048
ds_read_b64_tr_b16 v[152:153], v231 offset:2048
v_mfma_f32_32x32x16_bf16 v[62:77], v[198:201], v[178:181], v[62:77]
ds_read_b64_tr_b16 v[154:155], v232 offset:2048
ds_read_b64_tr_b16 v[156:157], v233 offset:2048
buffer_load_dwordx4 v224, s[96:99], s93 offen offset:2048  lds
s_waitcnt lgkmcnt(5)
ds_read_b128 v[134:137], v228 offset:0
v_mfma_f32_32x32x16_bf16 v[78:93], v[202:205], v[178:181], v[78:93]
ds_read_b64_tr_b16 v[158:159], v230 offset:32768
ds_read_b64_tr_b16 v[160:161], v231 offset:32768
ds_read_b64_tr_b16 v[162:163], v232 offset:32768
ds_read_b64_tr_b16 v[164:165], v233 offset:32768
buffer_load_dwordx4 v225, s[96:99], s93 offen offset:3072  lds
v_mfma_f32_32x32x16_bf16 v[62:77], v[206:209], v[182:185], v[62:77]
ds_read_b128 v[138:141], v229 offset:0
ds_read_b64_tr_b16 v[166:167], v230 offset:34816
ds_read_b64_tr_b16 v[168:169], v231 offset:34816
ds_read_b64_tr_b16 v[170:171], v232 offset:34816
ds_read_b64_tr_b16 v[172:173], v233 offset:34816
v_mfma_f32_32x32x16_bf16 v[78:93], v[210:213], v[182:185], v[78:93]
v_mfma_f32_32x32x16_bf16 v[62:77], v[214:217], v[186:189], v[62:77]
v_mfma_f32_32x32x16_bf16 v[78:93], v[218:221], v[186:189], v[78:93]
s_waitcnt vmcnt(4)
s_waitcnt lgkmcnt(0)
s_barrier
v_mfma_f32_32x32x16_bf16 v[62:77], v[142:145], v[126:129], v[62:77]
s_add_u32 m0, s60, 12288
s_add_u32 s93, s78, 7
s_and_b32 s93, s93, 15
s_lshl_b32 s93, s93, s77
s_add_u32 s93, s93, s76
buffer_load_dwordx4 v222, s[96:99], s93 offen offset:0  lds
ds_read_b128 v[174:177], v226 offset:4096
ds_read_b64_tr_b16 v[190:191], v230 offset:4096
ds_read_b64_tr_b16 v[192:193], v231 offset:4096
ds_read_b64_tr_b16 v[194:195], v232 offset:4096
v_mfma_f32_32x32x16_bf16 v[78:93], v[146:149], v[126:129], v[78:93]
ds_read_b64_tr_b16 v[196:197], v233 offset:4096
buffer_load_dwordx4 v223, s[96:99], s93 offen offset:1024  lds
ds_read_b128 v[178:181], v227 offset:4096
ds_read_b64_tr_b16 v[198:199], v230 offset:6144
ds_read_b64_tr_b16 v[200:201], v231 offset:6144
v_mfma_f32_32x32x16_bf16 v[62:77], v[150:153], v[130:133], v[62:77]
ds_read_b64_tr_b16 v[202:203], v232 offset:6144
ds_read_b64_tr_b16 v[204:205], v233 offset:6144
buffer_load_dwordx4 v224, s[96:99], s93 offen offset:2048  lds
s_waitcnt lgkmcnt(5)
ds_read_b128 v[182:185], v228 offset:4096
v_mfma_f32_32x32x16_bf16 v[78:93], v[154:157], v[130:133], v[78:93]
ds_read_b64_tr_b16 v[206:207], v230 offset:36864
ds_read_b64_tr_b16 v[208:209], v231 offset:36864
ds_read_b64_tr_b16 v[210:211], v232 offset:36864
ds_read_b64_tr_b16 v[212:213], v233 offset:36864
buffer_load_dwordx4 v225, s[96:99], s93 offen offset:3072  lds
v_mfma_f32_32x32x16_bf16 v[62:77], v[158:161], v[134:137], v[62:77]
ds_read_b128 v[186:189], v229 offset:4096
ds_read_b64_tr_b16 v[214:215], v230 offset:38912
ds_read_b64_tr_b16 v[216:217], v231 offset:38912
ds_read_b64_tr_b16 v[218:219], v232 offset:38912
ds_read_b64_tr_b16 v[220:221], v233 offset:38912
v_mfma_f32_32x32x16_bf16 v[78:93], v[162:165], v[134:137], v[78:93]
v_mfma_f32_32x32x16_bf16 v[62:77], v[166:169], v[138:141], v[62:77]
v_mfma_f32_32x32x16_bf16 v[78:93], v[170:173], v[138:141], v[78:93]
s_waitcnt vmcnt(4)
s_waitcnt lgkmcnt(0)
s_barrier
v_mfma_f32_32x32x16_bf16 v[62:77], v[190:193], v[174:177], v[62:77]
s_add_u32 m0, s60, 0
s_add_u32 s93, s78, 8
s_and_b32 s93, s93, 15
s_lshl_b32 s93, s93, s77
s_add_u32 s93, s93, s76
buffer_load_dwordx4 v222, s[96:99], s93 offen offset:0  lds
ds_read_b128 v[126:129], v226 offset:8192
ds_read_b64_tr_b16 v[142:143], v230 offset:8192
ds_read_b64_tr_b16 v[144:145], v231 offset:8192
ds_read_b64_tr_b16 v[146:147], v232 offset:8192
v_mfma_f32_32x32x16_bf16 v[78:93], v[194:197], v[174:177], v[78:93]
ds_read_b64_tr_b16 v[148:149], v233 offset:8192
buffer_load_dwordx4 v223, s[96:99], s93 offen offset:1024  lds
ds_read_b128 v[130:133], v227 offset:8192
ds_read_b64_tr_b16 v[150:151], v230 offset:10240
ds_read_b64_tr_b16 v[152:153], v231 offset:10240
v_mfma_f32_32x32x16_bf16 v[62:77], v[198:201], v[178:181], v[62:77]
ds_read_b64_tr_b16 v[154:155], v232 offset:10240
ds_read_b64_tr_b16 v[156:157], v233 offset:10240
buffer_load_dwordx4 v224, s[96:99], s93 offen offset:2048  lds
s_waitcnt lgkmcnt(5)
ds_read_b128 v[134:137], v228 offset:8192
v_mfma_f32_32x32x16_bf16 v[78:93], v[202:205], v[178:181], v[78:93]
ds_read_b64_tr_b16 v[158:159], v230 offset:40960
ds_read_b64_tr_b16 v[160:161], v231 offset:40960
ds_read_b64_tr_b16 v[162:163], v232 offset:40960
ds_read_b64_tr_b16 v[164:165], v233 offset:40960
buffer_load_dwordx4 v225, s[96:99], s93 offen offset:3072  lds
v_mfma_f32_32x32x16_bf16 v[62:77], v[206:209], v[182:185], v[62:77]
ds_read_b128 v[138:141], v229 offset:8192
ds_read_b64_tr_b16 v[166:167], v230 offset:43008
ds_read_b64_tr_b16 v[168:169], v231 offset:43008
ds_read_b64_tr_b16 v[170:171], v232 offset:43008
ds_read_b64_tr_b16 v[172:173], v233 offset:43008
v_mfma_f32_32x32x16_bf16 v[78:93], v[210:213], v[182:185], v[78:93]
v_mfma_f32_32x32x16_bf16 v[62:77], v[214:217], v[186:189], v[62:77]
v_mfma_f32_32x32x16_bf16 v[78:93], v[218:221], v[186:189], v[78:93]
s_waitcnt vmcnt(4)
s_waitcnt lgkmcnt(0)
s_barrier
v_mfma_f32_32x32x16_bf16 v[62:77], v[142:145], v[126:129], v[62:77]
s_add_u32 m0, s60, 4096
s_add_u32 s93, s78, 9
s_and_b32 s93, s93, 15
s_lshl_b32 s93, s93, s77
s_add_u32 s93, s93, s76
buffer_load_dwordx4 v222, s[96:99], s93 offen offset:0  lds
ds_read_b128 v[174:177], v226 offset:12288
ds_read_b64_tr_b16 v[190:191], v230 offset:12288
ds_read_b64_tr_b16 v[192:193], v231 offset:12288
ds_read_b64_tr_b16 v[194:195], v232 offset:12288
v_mfma_f32_32x32x16_bf16 v[78:93], v[146:149], v[126:129], v[78:93]
ds_read_b64_tr_b16 v[196:197], v233 offset:12288
buffer_load_dwordx4 v223, s[96:99], s93 offen offset:1024  lds
ds_read_b128 v[178:181], v227 offset:12288
ds_read_b64_tr_b16 v[198:199], v230 offset:14336
ds_read_b64_tr_b16 v[200:201], v231 offset:14336
v_mfma_f32_32x32x16_bf16 v[62:77], v[150:153], v[130:133], v[62:77]
ds_read_b64_tr_b16 v[202:203], v232 offset:14336
ds_read_b64_tr_b16 v[204:205], v233 offset:14336
buffer_load_dwordx4 v224, s[96:99], s93 offen offset:2048  lds
s_waitcnt lgkmcnt(5)
ds_read_b128 v[182:185], v228 offset:12288
v_mfma_f32_32x32x16_bf16 v[78:93], v[154:157], v[130:133], v[78:93]
ds_read_b64_tr_b16 v[206:207], v230 offset:45056
ds_read_b64_tr_b16 v[208:209], v231 offset:45056
ds_read_b64_tr_b16 v[210:211], v232 offset:45056
ds_read_b64_tr_b16 v[212:213], v233 offset:45056
buffer_load_dwordx4 v225, s[96:99], s93 offen offset:3072  lds
v_mfma_f32_32x32x16_bf16 v[62:77], v[158:161], v[134:137], v[62:77]
ds_read_b128 v[186:189], v229 offset:12288
ds_read_b64_tr_b16 v[214:215], v230 offset:47104
ds_read_b64_tr_b16 v[216:217], v231 offset:47104
ds_read_b64_tr_b16 v[218:219], v232 offset:47104
ds_read_b64_tr_b16 v[220:221], v233 offset:47104
v_mfma_f32_32x32x16_bf16 v[78:93], v[162:165], v[134:137], v[78:93]
v_mfma_f32_32x32x16_bf16 v[62:77], v[166:169], v[138:141], v[62:77]
v_mfma_f32_32x32x16_bf16 v[78:93], v[170:173], v[138:141], v[78:93]
s_waitcnt vmcnt(4)
s_waitcnt lgkmcnt(0)
s_barrier
v_mfma_f32_32x32x16_bf16 v[62:77], v[190:193], v[174:177], v[62:77]
s_add_u32 m0, s60, 8192
s_add_u32 s93, s78, 10
s_and_b32 s93, s93, 15
s_lshl_b32 s93, s93, s77
s_add_u32 s93, s93, s76
buffer_load_dwordx4 v222, s[96:99], s93 offen offset:0  lds
ds_read_b128 v[126:129], v226 offset:0
ds_read_b64_tr_b16 v[142:143], v230 offset:0
ds_read_b64_tr_b16 v[144:145], v231 offset:0
ds_read_b64_tr_b16 v[146:147], v232 offset:0
v_mfma_f32_32x32x16_bf16 v[78:93], v[194:197], v[174:177], v[78:93]
ds_read_b64_tr_b16 v[148:149], v233 offset:0
buffer_load_dwordx4 v223, s[96:99], s93 offen offset:1024  lds
ds_read_b128 v[130:133], v227 offset:0
ds_read_b64_tr_b16 v[150:151], v230 offset:2048
ds_read_b64_tr_b16 v[152:153], v231 offset:2048
v_mfma_f32_32x32x16_bf16 v[62:77], v[198:201], v[178:181], v[62:77]
ds_read_b64_tr_b16 v[154:155], v232 offset:2048
ds_read_b64_tr_b16 v[156:157], v233 offset:2048
buffer_load_dwordx4 v224, s[96:99], s93 offen offset:2048  lds
s_waitcnt lgkmcnt(5)
ds_read_b128 v[134:137], v228 offset:0
v_mfma_f32_32x32x16_bf16 v[78:93], v[202:205], v[178:181], v[78:93]
ds_read_b64_tr_b16 v[158:159], v230 offset:32768
ds_read_b64_tr_b16 v[160:161], v231 offset:32768
ds_read_b64_tr_b16 v[162:163], v232 offset:32768
ds_read_b64_tr_b16 v[164:165], v233 offset:32768
buffer_load_dwordx4 v225, s[96:99], s93 offen offset:3072  lds
v_mfma_f32_32x32x16_bf16 v[62:77], v[206:209], v[182:185], v[62:77]
ds_read_b128 v[138:141], v229 offset:0
ds_read_b64_tr_b16 v[166:167], v230 offset:34816
ds_read_b64_tr_b16 v[168:169], v231 offset:34816
ds_read_b64_tr_b16 v[170:171], v232 offset:34816
ds_read_b64_tr_b16 v[172:173], v233 offset:34816
v_mfma_f32_32x32x16_bf16 v[78:93], v[210:213], v[182:185], v[78:93]
v_mfma_f32_32x32x16_bf16 v[62:77], v[214:217], v[186:189], v[62:77]
v_mfma_f32_32x32x16_bf16 v[78:93], v[218:221], v[186:189], v[78:93]
s_waitcnt vmcnt(4)
s_waitcnt lgkmcnt(0)
s_barrier
v_mfma_f32_32x32x16_bf16 v[62:77], v[142:145], v[126:129], v[62:77]
s_add_u32 m0, s60, 12288
s_add_u32 s93, s78, 11
s_and_b32 s93, s93, 15
s_lshl_b32 s93, s93, s77
s_add_u32 s93, s93, s76
buffer_load_dwordx4 v222, s[96:99], s93 offen offset:0  lds
ds_read_b128 v[174:177], v226 offset:4096
ds_read_b64_tr_b16 v[190:191], v230 offset:4096
ds_read_b64_tr_b16 v[192:193], v231 offset:4096
ds_read_b64_tr_b16 v[194:195], v232 offset:4096
v_mfma_f32_32x32x16_bf16 v[78:93], v[146:149], v[126:129], v[78:93]
ds_read_b64_tr_b16 v[196:197], v233 offset:4096
buffer_load_dwordx4 v223, s[96:99], s93 offen offset:1024  lds
ds_read_b128 v[178:181], v227 offset:4096
ds_read_b64_tr_b16 v[198:199], v230 offset:6144
ds_read_b64_tr_b16 v[200:201], v231 offset:6144
v_mfma_f32_32x32x16_bf16 v[62:77], v[150:153], v[130:133], v[62:77]
ds_read_b64_tr_b16 v[202:203], v232 offset:6144
ds_read_b64_tr_b16 v[204:205], v233 offset:6144
buffer_load_dwordx4 v224, s[96:99], s93 offen offset:2048  lds
s_waitcnt lgkmcnt(5)
ds_read_b128 v[182:185], v228 offset:4096
v_mfma_f32_32x32x16_bf16 v[78:93], v[154:157], v[130:133], v[78:93]
ds_read_b64_tr_b16 v[206:207], v230 offset:36864
ds_read_b64_tr_b16 v[208:209], v231 offset:36864
ds_read_b64_tr_b16 v[210:211], v232 offset:36864
ds_read_b64_tr_b16 v[212:213], v233 offset:36864
buffer_load_dwordx4 v225, s[96:99], s93 offen offset:3072  lds
v_mfma_f32_32x32x16_bf16 v[62:77], v[158:161], v[134:137], v[62:77]
ds_read_b128 v[186:189], v229 offset:4096
ds_read_b64_tr_b16 v[214:215], v230 offset:38912
ds_read_b64_tr_b16 v[216:217], v231 offset:38912
ds_read_b64_tr_b16 v[218:219], v232 offset:38912
ds_read_b64_tr_b16 v[220:221], v233 offset:38912
v_mfma_f32_32x32x16_bf16 v[78:93], v[162:165], v[134:137], v[78:93]
v_mfma_f32_32x32x16_bf16 v[62:77], v[166:169], v[138:141], v[62:77]
v_mfma_f32_32x32x16_bf16 v[78:93], v[170:173], v[138:141], v[78:93]
s_waitcnt vmcnt(4)
v_lshlrev_b32 v10, 2, v0
buffer_load_dword v10, v10, s[52:55], 0 offen sc1
s_waitcnt lgkmcnt(0)
s_barrier
v_mfma_f32_32x32x16_bf16 v[62:77], v[190:193], v[174:177], v[62:77]
s_add_u32 m0, s60, 0
s_add_u32 s93, s78, 12
s_and_b32 s93, s93, 15
s_lshl_b32 s93, s93, s77
s_add_u32 s93, s93, s76
buffer_load_dwordx4 v222, s[96:99], s93 offen offset:0  lds
ds_read_b128 v[126:129], v226 offset:8192
ds_read_b64_tr_b16 v[142:143], v230 offset:8192
ds_read_b64_tr_b16 v[144:145], v231 offset:8192
v_mfma_f32_32x32x16_bf16 v[78:93], v[194:197], v[174:177], v[78:93]
ds_read_b64_tr_b16 v[146:147], v232 offset:8192
ds_read_b64_tr_b16 v[148:149], v233 offset:8192
buffer_load_dwordx4 v223, s[96:99], s93 offen offset:1024  lds
ds_read_b128 v[130:133], v227 offset:8192
ds_read_b64_tr_b16 v[150:151], v230 offset:10240
v_mfma_f32_32x32x16_bf16 v[62:77], v[198:201], v[178:181], v[62:77]
ds_read_b64_tr_b16 v[152:153], v231 offset:10240
ds_read_b64_tr_b16 v[154:155], v232 offset:10240
ds_read_b64_tr_b16 v[156:157], v233 offset:10240
buffer_load_dwordx4 v224, s[96:99], s93 offen offset:2048  lds
s_waitcnt lgkmcnt(5)
v_mfma_f32_32x32x16_bf16 v[78:93], v[202:205], v[178:181], v[78:93]
ds_read_b128 v[134:137], v228 offset:8192
ds_read_b64_tr_b16 v[158:159], v230 offset:40960
ds_read_b64_tr_b16 v[160:161], v231 offset:40960
ds_read_b64_tr_b16 v[162:163], v232 offset:40960
ds_read_b64_tr_b16 v[164:165], v233 offset:40960
v_mfma_f32_32x32x16_bf16 v[62:77], v[206:209], v[182:185], v[62:77]
ds_read_b128 v[138:141], v229 offset:8192
ds_read_b64_tr_b16 v[166:167], v230 offset:43008
ds_read_b64_tr_b16 v[168:169], v231 offset:43008
ds_read_b64_tr_b16 v[170:171], v232 offset:43008
ds_read_b64_tr_b16 v[172:173], v233 offset:43008
v_mfma_f32_32x32x16_bf16 v[78:93], v[210:213], v[182:185], v[78:93]
v_mfma_f32_32x32x16_bf16 v[62:77], v[214:217], v[186:189], v[62:77]
v_mfma_f32_32x32x16_bf16 v[78:93], v[218:221], v[186:189], v[78:93]
s_waitcnt vmcnt(4)
s_waitcnt lgkmcnt(0)
s_barrier
v_mfma_f32_32x32x16_bf16 v[62:77], v[142:145], v[126:129], v[62:77]
buffer_load_dwordx4 v225, s[96:99], s93 offen offset:3072  lds
ds_read_b128 v[174:177], v226 offset:12288
ds_read_b64_tr_b16 v[190:191], v230 offset:12288
ds_read_b64_tr_b16 v[192:193], v231 offset:12288
ds_read_b64_tr_b16 v[194:195], v232 offset:12288
v_mfma_f32_32x32x16_bf16 v[78:93], v[146:149], v[126:129], v[78:93]
ds_read_b64_tr_b16 v[196:197], v233 offset:12288
s_add_u32 m0, s60, 4096
s_add_u32 s93, s78, 13
s_and_b32 s93, s93, 15
s_lshl_b32 s93, s93, s77
s_add_u32 s93, s93, s76
buffer_load_dwordx4 v222, s[96:99], s93 offen offset:0  lds
ds_read_b128 v[178:181], v227 offset:12288
ds_read_b64_tr_b16 v[198:199], v230 offset:14336
ds_read_b64_tr_b16 v[200:201], v231 offset:14336
v_mfma_f32_32x32x16_bf16 v[62:77], v[150:153], v[130:133], v[62:77]
ds_read_b64_tr_b16 v[202:203], v232 offset:14336
ds_read_b64_tr_b16 v[204:205], v233 offset:14336
buffer_load_dwordx4 v223, s[96:99], s93 offen offset:1024  lds
s_waitcnt lgkmcnt(5)
ds_read_b128 v[182:185], v228 offset:12288
v_mfma_f32_32x32x16_bf16 v[78:93], v[154:157], v[130:133], v[78:93]
ds_read_b64_tr_b16 v[206:207], v230 offset:45056
ds_read_b64_tr_b16 v[208:209], v231 offset:45056
ds_read_b64_tr_b16 v[210:211], v232 offset:45056
ds_read_b64_tr_b16 v[212:213], v233 offset:45056
buffer_load_dwordx4 v224, s[96:99], s93 offen offset:2048  lds
v_mfma_f32_32x32x16_bf16 v[62:77], v[158:161], v[134:137], v[62:77]
ds_read_b128 v[186:189], v229 offset:12288
ds_read_b64_tr_b16 v[214:215], v230 offset:47104
ds_read_b64_tr_b16 v[216:217], v231 offset:47104
ds_read_b64_tr_b16 v[218:219], v232 offset:47104
ds_read_b64_tr_b16 v[220:221], v233 offset:47104
v_mfma_f32_32x32x16_bf16 v[78:93], v[162:165], v[134:137], v[78:93]
v_mfma_f32_32x32x16_bf16 v[62:77], v[166:169], v[138:141], v[62:77]
v_mfma_f32_32x32x16_bf16 v[78:93], v[170:173], v[138:141], v[78:93]
s_waitcnt vmcnt(3)
s_waitcnt lgkmcnt(0)
s_barrier
v_mfma_f32_32x32x16_bf16 v[62:77], v[190:193], v[174:177], v[62:77]
buffer_load_dwordx4 v225, s[96:99], s93 offen offset:3072  lds
ds_read_b128 v[126:129], v226 offset:0
ds_read_b64_tr_b16 v[142:143], v230 offset:0
ds_read_b64_tr_b16 v[144:145], v231 offset:0
ds_read_b64_tr_b16 v[146:147], v232 offset:0
v_mfma_f32_32x32x16_bf16 v[78:93], v[194:197], v[174:177], v[78:93]
ds_read_b64_tr_b16 v[148:149], v233 offset:0
s_add_u32 m0, s60, 8192
s_add_u32 s93, s78, 14
s_and_b32 s93, s93, 15
s_lshl_b32 s93, s93, s77
s_add_u32 s93, s93, s76
buffer_load_dwordx4 v222, s[96:99], s93 offen offset:0  lds
ds_read_b128 v[130:133], v227 offset:0
ds_read_b64_tr_b16 v[150:151], v230 offset:2048
ds_read_b64_tr_b16 v[152:153], v231 offset:2048
v_mfma_f32_32x32x16_bf16 v[62:77], v[198:201], v[178:181], v[62:77]
ds_read_b64_tr_b16 v[154:155], v232 offset:2048
ds_read_b64_tr_b16 v[156:157], v233 offset:2048
buffer_load_dwordx4 v223, s[96:99], s93 offen offset:1024  lds
s_waitcnt lgkmcnt(5)
ds_read_b128 v[134:137], v228 offset:0
v_mfma_f32_32x32x16_bf16 v[78:93], v[202:205], v[178:181], v[78:93]
ds_read_b64_tr_b16 v[158:159], v230 offset:32768
ds_read_b64_tr_b16 v[160:161], v231 offset:32768
ds_read_b64_tr_b16 v[162:163], v232 offset:32768
ds_read_b64_tr_b16 v[164:165], v233 offset:32768
buffer_load_dwordx4 v224, s[96:99], s93 offen offset:2048  lds
v_mfma_f32_32x32x16_bf16 v[62:77], v[206:209], v[182:185], v[62:77]
buffer_load_dwordx4 v225, s[96:99], s93 offen offset:3072  lds
ds_read_b128 v[138:141], v229 offset:0
ds_read_b64_tr_b16 v[166:167], v230 offset:34816
ds_read_b64_tr_b16 v[168:169], v231 offset:34816
ds_read_b64_tr_b16 v[170:171], v232 offset:34816
ds_read_b64_tr_b16 v[172:173], v233 offset:34816
v_mfma_f32_32x32x16_bf16 v[78:93], v[210:213], v[182:185], v[78:93]
v_mfma_f32_32x32x16_bf16 v[62:77], v[214:217], v[186:189], v[62:77]
v_mfma_f32_32x32x16_bf16 v[78:93], v[218:221], v[186:189], v[78:93]
s_waitcnt vmcnt(4)
s_waitcnt lgkmcnt(0)
s_barrier
v_mfma_f32_32x32x16_bf16 v[62:77], v[142:145], v[126:129], v[62:77]
s_add_u32 m0, s60, 12288
s_add_u32 s93, s78, 15
s_and_b32 s93, s93, 15
s_lshl_b32 s93, s93, s77
s_add_u32 s93, s93, s76
buffer_load_dwordx4 v222, s[96:99], s93 offen offset:0  lds
ds_read_b128 v[174:177], v226 offset:4096
ds_read_b64_tr_b16 v[190:191], v230 offset:4096
ds_read_b64_tr_b16 v[192:193], v231 offset:4096
ds_read_b64_tr_b16 v[194:195], v232 offset:4096
v_mfma_f32_32x32x16_bf16 v[78:93], v[146:149], v[126:129], v[78:93]
ds_read_b64_tr_b16 v[196:197], v233 offset:4096
buffer_load_dwordx4 v223, s[96:99], s93 offen offset:1024  lds
ds_read_b128 v[178:181], v227 offset:4096
ds_read_b64_tr_b16 v[198:199], v230 offset:6144
ds_read_b64_tr_b16 v[200:201], v231 offset:6144
v_mfma_f32_32x32x16_bf16 v[62:77], v[150:153], v[130:133], v[62:77]
ds_read_b64_tr_b16 v[202:203], v232 offset:6144
ds_read_b64_tr_b16 v[204:205], v233 offset:6144
buffer_load_dwordx4 v224, s[96:99], s93 offen offset:2048  lds
s_waitcnt lgkmcnt(5)
ds_read_b128 v[182:185], v228 offset:4096
v_mfma_f32_32x32x16_bf16 v[78:93], v[154:157], v[130:133], v[78:93]
ds_read_b64_tr_b16 v[206:207], v230 offset:36864
ds_read_b64_tr_b16 v[208:209], v231 offset:36864
ds_read_b64_tr_b16 v[210:211], v232 offset:36864
ds_read_b64_tr_b16 v[212:213], v233 offset:36864
buffer_load_dwordx4 v225, s[96:99], s93 offen offset:3072  lds
v_mfma_f32_32x32x16_bf16 v[62:77], v[158:161], v[134:137], v[62:77]
ds_read_b128 v[186:189], v229 offset:4096
ds_read_b64_tr_b16 v[214:215], v230 offset:38912
ds_read_b64_tr_b16 v[216:217], v231 offset:38912
ds_read_b64_tr_b16 v[218:219], v232 offset:38912
ds_read_b64_tr_b16 v[220:221], v233 offset:38912
v_mfma_f32_32x32x16_bf16 v[78:93], v[162:165], v[134:137], v[78:93]
v_mfma_f32_32x32x16_bf16 v[62:77], v[166:169], v[138:141], v[62:77]
v_mfma_f32_32x32x16_bf16 v[78:93], v[170:173], v[138:141], v[78:93]
s_waitcnt vmcnt(4)
v_cmp_gt_u32 vcc, 4, v10
s_nop 9
s_cbranch_vccz L_ok_16
s_mov_b32 s62, 0
v_lshlrev_b32 v254, 2, v0
s_nop 4
L_pollc_17:
buffer_load_dword v255, v254, s[52:55], 0 offen sc1
s_waitcnt vmcnt(0)
v_cmp_gt_u32 vcc, 4, v255
s_add_u32 s62, s62, 1
s_nop 2
s_cbranch_vccz L_pcdone_18
s_cmp_lt_u32 s62, 200000
s_cbranch_scc0 L_pcdone_18
s_sleep 8
s_branch L_pollc_17
L_pcdone_18:
L_ok_16:
s_waitcnt lgkmcnt(0)
s_barrier
v_mfma_f32_32x32x16_bf16 v[62:77], v[190:193], v[174:177], v[62:77]
ds_read_b128 v[126:129], v226 offset:8192
ds_read_b64_tr_b16 v[142:143], v230 offset:8192
ds_read_b64_tr_b16 v[144:145], v231 offset:8192
ds_read_b64_tr_b16 v[146:147], v232 offset:8192
v_mfma_f32_32x32x16_bf16 v[78:93], v[194:197], v[174:177], v[78:93]
ds_read_b64_tr_b16 v[148:149], v233 offset:8192
ds_read_b128 v[130:133], v227 offset:8192
ds_read_b64_tr_b16 v[150:151], v230 offset:10240
ds_read_b64_tr_b16 v[152:153], v231 offset:10240
v_mfma_f32_32x32x16_bf16 v[62:77], v[198:201], v[178:181], v[62:77]
ds_read_b64_tr_b16 v[154:155], v232 offset:10240
ds_read_b64_tr_b16 v[156:157], v233 offset:10240
s_waitcnt lgkmcnt(5)
ds_read_b128 v[134:137], v228 offset:8192
v_mfma_f32_32x32x16_bf16 v[78:93], v[202:205], v[178:181], v[78:93]
ds_read_b64_tr_b16 v[158:159], v230 offset:40960
ds_read_b64_tr_b16 v[160:161], v231 offset:40960
ds_read_b64_tr_b16 v[162:163], v232 offset:40960
ds_read_b64_tr_b16 v[164:165], v233 offset:40960
v_mfma_f32_32x32x16_bf16 v[62:77], v[206:209], v[182:185], v[62:77]
ds_read_b128 v[138:141], v229 offset:8192
ds_read_b64_tr_b16 v[166:167], v230 offset:43008
ds_read_b64_tr_b16 v[168:169], v231 offset:43008
ds_read_b64_tr_b16 v[170:171], v232 offset:43008
ds_read_b64_tr_b16 v[172:173], v233 offset:43008
v_mfma_f32_32x32x16_bf16 v[78:93], v[210:213], v[182:185], v[78:93]
v_mfma_f32_32x32x16_bf16 v[62:77], v[214:217], v[186:189], v[62:77]
v_mfma_f32_32x32x16_bf16 v[78:93], v[218:221], v[186:189], v[78:93]
s_waitcnt vmcnt(0)
s_waitcnt lgkmcnt(0)
s_barrier
v_mfma_f32_32x32x16_bf16 v[62:77], v[142:145], v[126:129], v[62:77]
ds_read_b128 v[174:177], v226 offset:12288
ds_read_b64_tr_b16 v[190:191], v230 offset:12288
ds_read_b64_tr_b16 v[192:193], v231 offset:12288
ds_read_b64_tr_b16 v[194:195], v232 offset:12288
v_mfma_f32_32x32x16_bf16 v[78:93], v[146:149], v[126:129], v[78:93]
ds_read_b64_tr_b16 v[196:197], v233 offset:12288
ds_read_b128 v[178:181], v227 offset:12288
ds_read_b64_tr_b16 v[198:199], v230 offset:14336
ds_read_b64_tr_b16 v[200:201], v231 offset:14336
ds_read_b64_tr_b16 v[202:203], v232 offset:14336
v_mfma_f32_32x32x16_bf16 v[62:77], v[150:153], v[130:133], v[62:77]
ds_read_b64_tr_b16 v[204:205], v233 offset:14336
s_waitcnt lgkmcnt(5)
ds_read_b128 v[182:185], v228 offset:12288
ds_read_b64_tr_b16 v[206:207], v230 offset:45056
ds_read_b64_tr_b16 v[208:209], v231 offset:45056
v_mfma_f32_32x32x16_bf16 v[78:93], v[154:157], v[130:133], v[78:93]
ds_read_b64_tr_b16 v[210:211], v232 offset:45056
ds_read_b64_tr_b16 v[212:213], v233 offset:45056
v_mfma_f32_32x32x16_bf16 v[62:77], v[158:161], v[134:137], v[62:77]
ds_read_b128 v[186:189], v229 offset:12288
ds_read_b64_tr_b16 v[214:215], v230 offset:47104
ds_read_b64_tr_b16 v[216:217], v231 offset:47104
ds_read_b64_tr_b16 v[218:219], v232 offset:47104
ds_read_b64_tr_b16 v[220:221], v233 offset:47104
v_mfma_f32_32x32x16_bf16 v[78:93], v[162:165], v[134:137], v[78:93]
v_mfma_f32_32x32x16_bf16 v[62:77], v[166:169], v[138:141], v[62:77]
v_mfma_f32_32x32x16_bf16 v[78:93], v[170:173], v[138:141], v[78:93]
s_waitcnt lgkmcnt(0)
s_barrier
v_mfma_f32_32x32x16_bf16 v[62:77], v[190:193], v[174:177], v[62:77]
v_mfma_f32_32x32x16_bf16 v[78:93], v[194:197], v[174:177], v[78:93]
v_mfma_f32_32x32x16_bf16 v[62:77], v[198:201], v[178:181], v[62:77]
v_mfma_f32_32x32x16_bf16 v[78:93], v[202:205], v[178:181], v[78:93]
v_mfma_f32_32x32x16_bf16 v[62:77], v[206:209], v[182:185], v[62:77]
v_mfma_f32_32x32x16_bf16 v[78:93], v[210:213], v[182:185], v[78:93]
v_mfma_f32_32x32x16_bf16 v[62:77], v[214:217], v[186:189], v[62:77]
v_mfma_f32_32x32x16_bf16 v[78:93], v[218:221], v[186:189], v[78:93]
s_mov_b32 s63, 0x3e0293ee
s_nop 9
v_mul_f32 v62, s63, v62
v_mul_f32 v63, s63, v63
v_mul_f32 v64, s63, v64
v_mul_f32 v65, s63, v65
v_mul_f32 v66, s63, v66
v_mul_f32 v67, s63, v67
v_mul_f32 v68, s63, v68
v_mul_f32 v69, s63, v69
v_cvt_pk_bf16_f32 v94, v62, v63
v_cvt_pk_bf16_f32 v95, v64, v65
v_cvt_pk_bf16_f32 v96, v66, v67
v_cvt_pk_bf16_f32 v97, v68, v69
buffer_store_dwordx4 v[94:97], v25, s[56:59], s73 offen offset:0 sc1
v_mul_f32 v70, s63, v70
v_mul_f32 v71, s63, v71
v_mul_f32 v72, s63, v72
v_mul_f32 v73, s63, v73
v_mul_f32 v74, s63, v74
v_mul_f32 v75, s63, v75
v_mul_f32 v76, s63, v76
v_mul_f32 v77, s63, v77
v_cvt_pk_bf16_f32 v98, v70, v71
v_cvt_pk_bf16_f32 v99, v72, v73
v_cvt_pk_bf16_f32 v100, v74, v75
v_cvt_pk_bf16_f32 v101, v76, v77
buffer_store_dwordx4 v[98:101], v25, s[56:59], s73 offen offset:1024 sc1
v_mul_f32 v78, s63, v78
v_mul_f32 v79, s63, v79
v_mul_f32 v80, s63, v80
v_mul_f32 v81, s63, v81
v_mul_f32 v82, s63, v82
v_mul_f32 v83, s63, v83
v_mul_f32 v84, s63, v84
v_mul_f32 v85, s63, v85
v_cvt_pk_bf16_f32 v102, v78, v79
v_cvt_pk_bf16_f32 v103, v80, v81
v_cvt_pk_bf16_f32 v104, v82, v83
v_cvt_pk_bf16_f32 v105, v84, v85
buffer_store_dwordx4 v[102:105], v25, s[56:59], s73 offen offset:2048 sc1
v_mul_f32 v86, s63, v86
v_mul_f32 v87, s63, v87
v_mul_f32 v88, s63, v88
v_mul_f32 v89, s63, v89
v_mul_f32 v90, s63, v90
v_mul_f32 v91, s63, v91
v_mul_f32 v92, s63, v92
v_mul_f32 v93, s63, v93
v_cvt_pk_bf16_f32 v106, v86, v87
v_cvt_pk_bf16_f32 v107, v88, v89
v_cvt_pk_bf16_f32 v108, v90, v91
v_cvt_pk_bf16_f32 v109, v92, v93
buffer_store_dwordx4 v[106:109], v25, s[56:59], s73 offen offset:3072 sc1
s_add_u32 m0, s60, 0
s_add_u32 s93, s69, 0
s_and_b32 s93, s93, 3
s_lshl_b32 s93, s93, 16
s_add_u32 s93, s93, s79
buffer_load_dwordx4 v1, s[12:15], s93 offen offset:0  lds
buffer_load_dwordx4 v2, s[12:15], s93 offen offset:1024  lds
buffer_load_dwordx4 v3, s[12:15], s93 offen offset:2048  lds
s_waitcnt vmcnt(3)
v_mov_b32 v254, 1
s_mov_b64 exec, 1
buffer_store_dword v254, off, s[56:59], s74 offset:0 sc1
s_mov_b64 exec, -1
buffer_load_dwordx4 v4, s[12:15], s93 offen offset:3072  lds
s_add_u32 m0, s60, 4096
s_add_u32 s93, s69, 0
s_and_b32 s93, s93, 3
s_lshl_b32 s93, s93, 16
s_add_u32 s93, s93, s79
s_add_u32 s93, s93, 128
buffer_load_dwordx4 v1, s[12:15], s93 offen offset:0  lds
s_waitcnt vmcnt(5)
buffer_load_dwordx4 v2, s[12:15], s93 offen offset:1024  lds
s_waitcnt vmcnt(5)
buffer_load_dwordx4 v3, s[12:15], s93 offen offset:2048  lds
s_waitcnt vmcnt(5)
buffer_load_dwordx4 v4, s[12:15], s93 offen offset:3072  lds
s_add_u32 m0, s60, 8192
s_add_u32 s93, s69, 1
s_and_b32 s93, s93, 3
s_lshl_b32 s93, s93, 16
s_add_u32 s93, s93, s79
s_waitcnt vmcnt(5)
buffer_load_dwordx4 v1, s[12:15], s93 offen offset:0  lds
s_waitcnt vmcnt(5)
buffer_load_dwordx4 v2, s[12:15], s93 offen offset:1024  lds
s_waitcnt vmcnt(5)
buffer_load_dwordx4 v3, s[12:15], s93 offen offset:2048  lds
s_waitcnt vmcnt(5)
buffer_load_dwordx4 v4, s[12:15], s93 offen offset:3072  lds
s_add_u32 m0, s60, 12288
s_add_u32 s93, s69, 1
s_and_b32 s93, s93, 3
s_lshl_b32 s93, s93, 16
s_add_u32 s93, s93, s79
s_add_u32 s93, s93, 128
s_waitcnt vmcnt(5)
buffer_load_dwordx4 v1, s[12:15], s93 offen offset:0  lds
s_waitcnt vmcnt(5)
buffer_load_dwordx4 v2, s[12:15], s93 offen offset:1024  lds
s_waitcnt vmcnt(5)
buffer_load_dwordx4 v3, s[12:15], s93 offen offset:2048  lds
s_lshl_b32 s74, s67, 12
s_lshl_b32 s61, s68, 7
s_add_u32 s74, s74, s61
s_add_u32 s74, s74, 10551296
v_and_b32 v12, 1, v0
v_lshlrev_b32 v12, 2, v12
v_bfe_u32 v254, v0, 1, 1
v_lshl_add_u32 v12, v254, 7, v12
buffer_load_dword v10, v12, s[56:59], s74 offen sc1
s_waitcnt vmcnt(0)
s_mov_b32 s62, 0
s_nop 4
L_chk_19:
v_cmp_ne_u32 vcc, 1, v10
s_add_u32 s62, s62, 1
s_nop 2
s_cbranch_vccz L_ok_20
s_cmp_lt_u32 s62, 200000
s_cbranch_scc0 L_ok_20
s_sleep 4
buffer_load_dword v10, v12, s[56:59], s74 offen sc1
s_waitcnt vmcnt(0)
s_branch L_chk_19
L_ok_20:
s_add_u32 s73, s71, 4194304
s_lshl_b32 s61, s3, 11
s_add_u32 s62, s61, 131072
s_add_u32 s61, s61, s73
s_mov_b32 s63, m0
s_mov_b32 m0, s62
s_nop 0
buffer_load_dwordx4 v25, s[56:59], s61 offen offset:0 sc1 lds
buffer_load_dwordx4 v25, s[56:59], s61 offen offset:1024 sc1 lds
s_mov_b32 m0, s63
s_lshr_b32 s80, s5, 1
s_and_b32 s61, s5, 1
s_lshl_b32 s81, s4, 1
s_add_u32 s81, s81, s61
s_lshl_b32 s82, s80, 18
s_lshl_b32 s61, s3, 15
s_add_u32 s82, s82, s61
s_lshl_b32 s83, s80, 12
s_lshl_b32 s61, s3, 9
s_add_u32 s83, s83, s61
s_add_u32 s83, s83, 10518528
s_lshl_b32 s6, s80, 17
s_lshl_b32 s61, s81, 7
s_add_u32 s6, s6, s61
s_add_u32 s82, s82, 2097152
s_add_u32 s6, s6, 2048
s_lshr_b32 s67, s80, 2
s_lshl_b32 s67, s67, 1
s_lshl_b32 s61, s67, 7
s_add_u32 s83, s83, s61
s_lshl_b32 s61, s67, 13
s_add_u32 s82, s82, s61
s_and_b32 s61, s81, 1
s_lshl_b32 s61, s61, 2
s_add_u32 s68, s80, s61
s_lshl_b32 s70, s3, 20
s_lshl_b32 s61, s81, 7
s_add_u32 s70, s70, s61
s_lshl_b32 s61, s67, 18
s_add_u32 s70, s70, s61
s_lshl_b32 s65, s64, 14
s_lshl_b32 s61, s4, 9
s_add_u32 s65, s65, s61
s_add_u32 s65, s65, 10485760
s_waitcnt vmcnt(0)
v_add_u32 v254, 131072, v25
s_barrier
ds_read_b128 v[62:65], v254 offset:0
ds_read_b128 v[66:69], v254 offset:1024
ds_read_b128 v[70:73], v254 offset:2048
ds_read_b128 v[74:77], v254 offset:3072
ds_read_b128 v[78:81], v254 offset:4096
ds_read_b128 v[82:85], v254 offset:5120
ds_read_b128 v[86:89], v254 offset:6144
ds_read_b128 v[90:93], v254 offset:7168
ds_read_b128 v[94:97], v254 offset:8192
ds_read_b128 v[98:101], v254 offset:9216
ds_read_b128 v[102:105], v254 offset:10240
ds_read_b128 v[106:109], v254 offset:11264
s_waitcnt lgkmcnt(4)
ds_read_b128 v[110:113], v254 offset:12288
ds_read_b128 v[114:117], v254 offset:13312
ds_read_b128 v[118:121], v254 offset:14336
ds_read_b128 v[122:125], v254 offset:15360
s_waitcnt lgkmcnt(0)
ds_read_b128 v[30:33], v13 offset:0
ds_read_b128 v[34:37], v14 offset:0
ds_read_b128 v[38:41], v15 offset:0
ds_read_b128 v[42:45], v16 offset:0
s_waitcnt lgkmcnt(0)
v_mfma_f32_32x32x16_bf16 v[126:141], v[30:33], v[62:65], 0
ds_read_b128 v[46:49], v13 offset:4096
v_mfma_f32_32x32x16_bf16 v[190:205], v[30:33], v[94:97], 0
buffer_load_dwordx4 v4, s[12:15], s93 offen offset:3072  lds
v_mfma_f32_32x32x16_bf16 v[126:141], v[34:37], v[66:69], v[126:141]
ds_read_b128 v[50:53], v14 offset:4096
v_mfma_f32_32x32x16_bf16 v[190:205], v[34:37], v[98:101], v[190:205]
s_add_u32 m0, s60, 0
s_add_u32 s93, s69, 2
s_and_b32 s93, s93, 3
s_lshl_b32 s93, s93, 16
s_add_u32 s93, s93, s79
buffer_load_dwordx4 v1, s[12:15], s93 offen offset:0  lds
v_mfma_f32_32x32x16_bf16 v[126:141], v[38:41], v[70:73], v[126:141]
ds_read_b128 v[54:57], v15 offset:4096
v_mfma_f32_32x32x16_bf16 v[190:205], v[38:41], v[102:105], v[190:205]
buffer_load_dwordx4 v2, s[12:15], s93 offen offset:1024  lds
v_mfma_f32_32x32x16_bf16 v[126:141], v[42:45], v[74:77], v[126:141]
ds_read_b128 v[58:61], v16 offset:4096
v_mfma_f32_32x32x16_bf16 v[190:205], v[42:45], v[106:109], v[190:205]
buffer_load_dwordx4 v3, s[12:15], s93 offen offset:2048  lds
s_waitcnt lgkmcnt(0)
v_mfma_f32_32x32x16_bf16 v[126:141], v[46:49], v[78:81], v[126:141]
v_mfma_f32_32x32x16_bf16 v[190:205], v[46:49], v[110:113], v[190:205]
ds_read_b128 v[30:33], v13 offset:8192
v_mfma_f32_32x32x16_bf16 v[126:141], v[50:53], v[82:85], v[126:141]
v_mfma_f32_32x32x16_bf16 v[190:205], v[50:53], v[114:117], v[190:205]
ds_read_b128 v[34:37], v14 offset:8192
v_mfma_f32_32x32x16_bf16 v[126:141], v[54:57], v[86:89], v[126:141]
v_mfma_f32_32x32x16_bf16 v[190:205], v[54:57], v[118:121], v[190:205]
ds_read_b128 v[38:41], v15 offset:8192
v_mfma_f32_32x32x16_bf16 v[126:141], v[58:61], v[90:93], v[126:141]
v_mfma_f32_32x32x16_bf16 v[190:205], v[58:61], v[122:125], v[190:205]
ds_read_b128 v[42:45], v16 offset:8192
s_waitcnt vmcnt(3)
s_waitcnt lgkmcnt(0)
v_mfma_f32_32x32x16_bf16 v[142:157], v[30:33], v[62:65], 0
v_mfma_f32_32x32x16_bf16 v[206:221], v[30:33], v[94:97], 0
ds_read_b128 v[46:49], v13 offset:12288
v_mfma_f32_32x32x16_bf16 v[142:157], v[34:37], v[66:69], v[142:157]
v_mfma_f32_32x32x16_bf16 v[206:221], v[34:37], v[98:101], v[206:221]
ds_read_b128 v[50:53], v14 offset:12288
v_mfma_f32_32x32x16_bf16 v[142:157], v[38:41], v[70:73], v[142:157]
buffer_load_dwordx4 v4, s[12:15], s93 offen offset:3072  lds
v_mfma_f32_32x32x16_bf16 v[206:221], v[38:41], v[102:105], v[206:221]
v_mfma_f32_32x32x16_bf16 v[142:157], v[42:45], v[74:77], v[142:157]
ds_read_b128 v[54:57], v15 offset:12288
v_mfma_f32_32x32x16_bf16 v[206:221], v[42:45], v[106:109], v[206:221]
ds_read_b128 v[58:61], v16 offset:12288
s_waitcnt vmcnt(0)
s_waitcnt lgkmcnt(0)
v_mfma_f32_32x32x16_bf16 v[142:157], v[46:49], v[78:81], v[142:157]
ds_read_b128 v[30:33], v13 offset:0
v_mfma_f32_32x32x16_bf16 v[206:221], v[46:49], v[110:113], v[206:221]
s_add_u32 m0, s60, 4096
s_add_u32 s93, s69, 2
s_and_b32 s93, s93, 3
s_lshl_b32 s93, s93, 16
s_add_u32 s93, s93, s79
s_add_u32 s93, s93, 128
buffer_load_dwordx4 v1, s[12:15], s93 offen offset:0  lds
v_mfma_f32_32x32x16_bf16 v[142:157], v[50:53], v[82:85], v[142:157]
ds_read_b128 v[34:37], v14 offset:0
v_mfma_f32_32x32x16_bf16 v[206:221], v[50:53], v[114:117], v[206:221]
buffer_load_dwordx4 v2, s[12:15], s93 offen offset:1024  lds
v_mfma_f32_32x32x16_bf16 v[142:157], v[54:57], v[86:89], v[142:157]
ds_read_b128 v[38:41], v15 offset:0
v_mfma_f32_32x32x16_bf16 v[206:221], v[54:57], v[118:121], v[206:221]
buffer_load_dwordx4 v3, s[12:15], s93 offen offset:2048  lds
v_mfma_f32_32x32x16_bf16 v[142:157], v[58:61], v[90:93], v[142:157]
ds_read_b128 v[42:45], v16 offset:0
v_mfma_f32_32x32x16_bf16 v[206:221], v[58:61], v[122:125], v[206:221]
buffer_load_dwordx4 v4, s[12:15], s93 offen offset:3072  lds
s_waitcnt vmcnt(0)
s_waitcnt lgkmcnt(0)
v_mfma_f32_32x32x16_bf16 v[158:173], v[30:33], v[62:65], 0
ds_read_b128 v[46:49], v13 offset:4096
v_mfma_f32_32x32x16_bf16 v[222:237], v[30:33], v[94:97], 0
s_add_u32 m0, s60, 8192
s_add_u32 s93, s69, 3
s_and_b32 s93, s93, 3
s_lshl_b32 s93, s93, 16
s_add_u32 s93, s93, s79
buffer_load_dwordx4 v1, s[12:15], s93 offen offset:0  lds
v_mfma_f32_32x32x16_bf16 v[158:173], v[34:37], v[66:69], v[158:173]
ds_read_b128 v[50:53], v14 offset:4096
v_mfma_f32_32x32x16_bf16 v[222:237], v[34:37], v[98:101], v[222:237]
buffer_load_dwordx4 v2, s[12:15], s93 offen offset:1024  lds
v_mfma_f32_32x32x16_bf16 v[158:173], v[38:41], v[70:73], v[158:173]
ds_read_b128 v[54:57], v15 offset:4096
v_mfma_f32_32x32x16_bf16 v[222:237], v[38:41], v[102:105], v[222:237]
buffer_load_dwordx4 v3, s[12:15], s93 offen offset:2048  lds
v_mfma_f32_32x32x16_bf16 v[158:173], v[42:45], v[74:77], v[158:173]
ds_read_b128 v[58:61], v16 offset:4096
v_mfma_f32_32x32x16_bf16 v[222:237], v[42:45], v[106:109], v[222:237]
buffer_load_dwordx4 v4, s[12:15], s93 offen offset:3072  lds
s_waitcnt vmcnt(0)
s_waitcnt lgkmcnt(0)
v_mfma_f32_32x32x16_bf16 v[158:173], v[46:49], v[78:81], v[158:173]
ds_read_b128 v[30:33], v13 offset:8192
v_mfma_f32_32x32x16_bf16 v[222:237], v[46:49], v[110:113], v[222:237]
s_add_u32 m0, s60, 12288
s_add_u32 s93, s69, 3
s_and_b32 s93, s93, 3
s_lshl_b32 s93, s93, 16
s_add_u32 s93, s93, s79
s_add_u32 s93, s93, 128
buffer_load_dwordx4 v1, s[12:15], s93 offen offset:0  lds
v_mfma_f32_32x32x16_bf16 v[158:173], v[50:53], v[82:85], v[158:173]
ds_read_b128 v[34:37], v14 offset:8192
v_mfma_f32_32x32x16_bf16 v[222:237], v[50:53], v[114:117], v[222:237]
buffer_load_dwordx4 v2, s[12:15], s93 offen offset:1024  lds
v_mfma_f32_32x32x16_bf16 v[158:173], v[54:57], v[86:89], v[158:173]
ds_read_b128 v[38:41], v15 offset:8192
v_mfma_f32_32x32x16_bf16 v[222:237], v[54:57], v[118:121], v[222:237]
buffer_load_dwordx4 v3, s[12:15], s93 offen offset:2048  lds
v_mfma_f32_32x32x16_bf16 v[158:173], v[58:61], v[90:93], v[158:173]
ds_read_b128 v[42:45], v16 offset:8192
v_mfma_f32_32x32x16_bf16 v[222:237], v[58:61], v[122:125], v[222:237]
buffer_load_dwordx4 v4, s[12:15], s93 offen offset:3072  lds
s_waitcnt vmcnt(0)
s_waitcnt lgkmcnt(0)
v_mfma_f32_32x32x16_bf16 v[174:189], v[30:33], v[62:65], 0
ds_read_b128 v[46:49], v13 offset:12288
v_mfma_f32_32x32x16_bf16 v[238:253], v[30:33], v[94:97], 0
s_add_u32 m0, s60, 0
s_add_u32 s93, s69, 0
s_and_b32 s93, s93, 3
s_lshl_b32 s93, s93, 16
s_add_u32 s93, s93, s79
buffer_load_dwordx4 v1, s[16:19], s93 offen offset:0  lds
v_mfma_f32_32x32x16_bf16 v[174:189], v[34:37], v[66:69], v[174:189]
ds_read_b128 v[50:53], v14 offset:12288
v_mfma_f32_32x32x16_bf16 v[238:253], v[34:37], v[98:101], v[238:253]
buffer_load_dwordx4 v2, s[16:19], s93 offen offset:1024  lds
v_mfma_f32_32x32x16_bf16 v[174:189], v[38:41], v[70:73], v[174:189]
ds_read_b128 v[54:57], v15 offset:12288
v_mfma_f32_32x32x16_bf16 v[238:253], v[38:41], v[102:105], v[238:253]
buffer_load_dwordx4 v3, s[16:19], s93 offen offset:2048  lds
v_mfma_f32_32x32x16_bf16 v[174:189], v[42:45], v[74:77], v[174:189]
ds_read_b128 v[58:61], v16 offset:12288
v_mfma_f32_32x32x16_bf16 v[238:253], v[42:45], v[106:109], v[238:253]
buffer_load_dwordx4 v4, s[16:19], s93 offen offset:3072  lds
s_waitcnt lgkmcnt(0)
v_mfma_f32_32x32x16_bf16 v[174:189], v[46:49], v[78:81], v[174:189]
v_mfma_f32_32x32x16_bf16 v[238:253], v[46:49], v[110:113], v[238:253]
v_mfma_f32_32x32x16_bf16 v[174:189], v[50:53], v[82:85], v[174:189]
v_mfma_f32_32x32x16_bf16 v[238:253], v[50:53], v[114:117], v[238:253]
v_mfma_f32_32x32x16_bf16 v[174:189], v[54:57], v[86:89], v[174:189]
v_mfma_f32_32x32x16_bf16 v[238:253], v[54:57], v[118:121], v[238:253]
v_mfma_f32_32x32x16_bf16 v[174:189], v[58:61], v[90:93], v[174:189]
v_mfma_f32_32x32x16_bf16 v[238:253], v[58:61], v[122:125], v[238:253]
v_and_b32 v255, 31, v0
v_lshlrev_b32 v255, 5, v255
v_add_u32 v255, 147456, v255
s_lshl_b32 s61, s3, 2
v_add_u32 v254, s61, v255
v_max3_f32 v30, v126, v127, v128
v_max3_f32 v31, v142, v143, v144
v_max3_f32 v32, v158, v159, v160
s_nop 2
v_max3_f32 v33, v174, v175, v176
v_max3_f32 v30, v30, v129, v130
v_max3_f32 v31, v31, v145, v146
v_max3_f32 v32, v32, v161, v162
v_max3_f32 v33, v33, v177, v178
v_max3_f32 v30, v30, v131, v132
v_max3_f32 v31, v31, v147, v148
v_max3_f32 v32, v32, v163, v164
v_max3_f32 v33, v33, v179, v180
v_max3_f32 v30, v30, v133, v134
v_max3_f32 v31, v31, v149, v150
v_max3_f32 v32, v32, v165, v166
v_max3_f32 v33, v33, v181, v182
v_max3_f32 v30, v30, v135, v136
v_max3_f32 v31, v31, v151, v152
v_max3_f32 v32, v32, v167, v168
v_max3_f32 v33, v33, v183, v184
v_max3_f32 v30, v30, v137, v138
v_max3_f32 v31, v31, v153, v154
v_max3_f32 v32, v32, v169, v170
v_max3_f32 v33, v33, v185, v186
v_max3_f32 v30, v30, v139, v140
v_max3_f32 v31, v31, v155, v156
v_max3_f32 v32, v32, v171, v172
v_max3_f32 v33, v33, v187, v188
v_max3_f32 v30, v30, v141, v157
v_max3_f32 v31, v31, v173, v189
v_max3_f32 v30, v30, v32, v33
v_max_f32 v26, v30, v31
v_mov_b32 v30, v26
s_nop 1
v_permlane32_swap_b32 v26, v30
v_max_f32 v26, v26, v30
ds_write_b32 v254, v26 offset:0
v_max3_f32 v30, v190, v191, v192
v_max3_f32 v31, v206, v207, v208
v_max3_f32 v32, v222, v223, v224
v_max3_f32 v33, v238, v239, v240
v_max3_f32 v30, v30, v193, v194
v_max3_f32 v31, v31, v209, v210
v_max3_f32 v32, v32, v225, v226
v_max3_f32 v33, v33, v241, v242
v_max3_f32 v30, v30, v195, v196
v_max3_f32 v31, v31, v211, v212
v_max3_f32 v32, v32, v227, v228
v_max3_f32 v33, v33, v243, v244
v_max3_f32 v30, v30, v197, v198
v_max3_f32 v31, v31, v213, v214
v_max3_f32 v32, v32, v229, v230
v_max3_f32 v33, v33, v245, v246
v_max3_f32 v30, v30, v199, v200
v_max3_f32 v31, v31, v215, v216
v_max3_f32 v32, v32, v231, v232
v_max3_f32 v33, v33, v247, v248
v_max3_f32 v30, v30, v201, v202
v_max3_f32 v31, v31, v217, v218
v_max3_f32 v32, v32, v233, v234
v_max3_f32 v33, v33, v249, v250
v_max3_f32 v30, v30, v203, v204
v_max3_f32 v31, v31, v219, v220
v_max3_f32 v32, v32, v235, v236
v_max3_f32 v33, v33, v251, v252
v_max3_f32 v30, v30, v205, v221
v_max3_f32 v31, v31, v237, v253
v_max3_f32 v30, v30, v32, v33
v_max_f32 v27, v30, v31
v_mov_b32 v30, v27
s_nop 1
v_permlane32_swap_b32 v27, v30
v_max_f32 v27, v27, v30
ds_write_b32 v254, v27 offset:2048
s_add_u32 m0, s60, 4096
s_add_u32 s93, s69, 0
s_and_b32 s93, s93, 3
s_lshl_b32 s93, s93, 16
s_add_u32 s93, s93, s79
s_add_u32 s93, s93, 128
buffer_load_dwordx4 v1, s[16:19], s93 offen offset:0  lds
buffer_load_dwordx4 v2, s[16:19], s93 offen offset:1024  lds
s_waitcnt lgkmcnt(0)
s_barrier
ds_read_b128 v[30:33], v255 offset:0
ds_read_b128 v[34:37], v255 offset:16
ds_read_b128 v[38:41], v255 offset:2048
ds_read_b128 v[42:45], v255 offset:2064
s_waitcnt lgkmcnt(2)
v_max3_f32 v30, v30, v31, v32
v_max3_f32 v33, v33, v34, v35
v_max3_f32 v30, v30, v36, v37
v_max_f32 v26, v30, v33
s_waitcnt lgkmcnt(0)
v_max3_f32 v38, v38, v39, v40
v_max3_f32 v41, v41, v42, v43
v_max3_f32 v38, v38, v44, v45
v_max_f32 v27, v38, v41
v_sub_f32 v126, v126, v26
v_sub_f32 v127, v127, v26
v_sub_f32 v128, v128, v26
v_sub_f32 v129, v129, v26
v_sub_f32 v130, v130, v26
v_sub_f32 v131, v131, v26
v_sub_f32 v132, v132, v26
v_sub_f32 v133, v133, v26
v_exp_f32 v126, v126
v_exp_f32 v127, v127
v_exp_f32 v128, v128
v_exp_f32 v129, v129
v_exp_f32 v130, v130
v_exp_f32 v131, v131
v_exp_f32 v132, v132
v_exp_f32 v133, v133
v_add_f32 v30, v126, v130
v_add_f32 v31, v127, v131
v_add_f32 v32, v128, v132
v_add_f32 v33, v129, v133
v_cvt_pk_bf16_f32 v62, v126, v127
v_cvt_pk_bf16_f32 v63, v128, v129
v_cvt_pk_bf16_f32 v64, v130, v131
v_cvt_pk_bf16_f32 v65, v132, v133
v_sub_f32 v134, v134, v26
v_sub_f32 v135, v135, v26
v_sub_f32 v136, v136, v26
v_sub_f32 v137, v137, v26
v_sub_f32 v138, v138, v26
v_sub_f32 v139, v139, v26
v_sub_f32 v140, v140, v26
v_sub_f32 v141, v141, v26
v_exp_f32 v134, v134
v_exp_f32 v135, v135
v_exp_f32 v136, v136
v_exp_f32 v137, v137
v_exp_f32 v138, v138
v_exp_f32 v139, v139
v_exp_f32 v140, v140
v_exp_f32 v141, v141
v_add_f32 v30, v30, v134
v_add_f32 v31, v31, v135
v_add_f32 v32, v32, v136
v_add_f32 v33, v33, v137
v_add_f32 v30, v30, v138
v_add_f32 v31, v31, v139
v_add_f32 v32, v32, v140
v_add_f32 v33, v33, v141
v_cvt_pk_bf16_f32 v66, v134, v135
v_cvt_pk_bf16_f32 v67, v136, v137
v_cvt_pk_bf16_f32 v68, v138, v139
v_cvt_pk_bf16_f32 v69, v140, v141
buffer_load_dwordx4 v3, s[16:19], s93 offen offset:2048  lds
v_sub_f32 v142, v142, v26
v_sub_f32 v143, v143, v26
v_sub_f32 v144, v144, v26
v_sub_f32 v145, v145, v26
v_sub_f32 v146, v146, v26
v_sub_f32 v147, v147, v26
v_sub_f32 v148, v148, v26
v_sub_f32 v149, v149, v26
v_exp_f32 v142, v142
v_exp_f32 v143, v143
v_exp_f32 v144, v144
v_exp_f32 v145, v145
v_exp_f32 v146, v146
v_exp_f32 v147, v147
v_exp_f32 v148, v148
v_exp_f32 v149, v149
v_add_f32 v30, v30, v142
v_add_f32 v31, v31, v143
v_add_f32 v32, v32, v144
v_add_f32 v33, v33, v145
v_add_f32 v30, v30, v146
v_add_f32 v31, v31, v147
v_add_f32 v32, v32, v148
v_add_f32 v33, v33, v149
v_cvt_pk_bf16_f32 v70, v142, v143
v_cvt_pk_bf16_f32 v71, v144, v145
v_cvt_pk_bf16_f32 v72, v146, v147
v_cvt_pk_bf16_f32 v73, v148, v149
v_sub_f32 v150, v150, v26
v_sub_f32 v151, v151, v26
v_sub_f32 v152, v152, v26
v_sub_f32 v153, v153, v26
v_sub_f32 v154, v154, v26
v_sub_f32 v155, v155, v26
v_sub_f32 v156, v156, v26
v_sub_f32 v157, v157, v26
v_exp_f32 v150, v150
v_exp_f32 v151, v151
v_exp_f32 v152, v152
v_exp_f32 v153, v153
v_exp_f32 v154, v154
v_exp_f32 v155, v155
v_exp_f32 v156, v156
v_exp_f32 v157, v157
v_add_f32 v30, v30, v150
v_add_f32 v31, v31, v151
v_add_f32 v32, v32, v152
v_add_f32 v33, v33, v153
v_add_f32 v30, v30, v154
v_add_f32 v31, v31, v155
v_add_f32 v32, v32, v156
v_add_f32 v33, v33, v157
v_cvt_pk_bf16_f32 v74, v150, v151
v_cvt_pk_bf16_f32 v75, v152, v153
v_cvt_pk_bf16_f32 v76, v154, v155
v_cvt_pk_bf16_f32 v77, v156, v157
buffer_load_dwordx4 v4, s[16:19], s93 offen offset:3072  lds
v_sub_f32 v158, v158, v26
v_sub_f32 v159, v159, v26
v_sub_f32 v160, v160, v26
v_sub_f32 v161, v161, v26
v_sub_f32 v162, v162, v26
v_sub_f32 v163, v163, v26
v_sub_f32 v164, v164, v26
v_sub_f32 v165, v165, v26
v_exp_f32 v158, v158
v_exp_f32 v159, v159
v_exp_f32 v160, v160
v_exp_f32 v161, v161
v_exp_f32 v162, v162
v_exp_f32 v163, v163
v_exp_f32 v164, v164
v_exp_f32 v165, v165
v_add_f32 v30, v30, v158
v_add_f32 v31, v31, v159
v_add_f32 v32, v32, v160
v_add_f32 v33, v33, v161
v_add_f32 v30, v30, v162
v_add_f32 v31, v31, v163
v_add_f32 v32, v32, v164
v_add_f32 v33, v33, v165
v_cvt_pk_bf16_f32 v78, v158, v159
v_cvt_pk_bf16_f32 v79, v160, v161
v_cvt_pk_bf16_f32 v80, v162, v163
v_cvt_pk_bf16_f32 v81, v164, v165
v_sub_f32 v166, v166, v26
v_sub_f32 v167, v167, v26
v_sub_f32 v168, v168, v26
v_sub_f32 v169, v169, v26
v_sub_f32 v170, v170, v26
v_sub_f32 v171, v171, v26
v_sub_f32 v172, v172, v26
v_sub_f32 v173, v173, v26
v_exp_f32 v166, v166
v_exp_f32 v167, v167
v_exp_f32 v168, v168
v_exp_f32 v169, v169
v_exp_f32 v170, v170
v_exp_f32 v171, v171
v_exp_f32 v172, v172
v_exp_f32 v173, v173
v_add_f32 v30, v30, v166
v_add_f32 v31, v31, v167
v_add_f32 v32, v32, v168
v_add_f32 v33, v33, v169
v_add_f32 v30, v30, v170
v_add_f32 v31, v31, v171
v_add_f32 v32, v32, v172
v_add_f32 v33, v33, v173
v_cvt_pk_bf16_f32 v82, v166, v167
v_cvt_pk_bf16_f32 v83, v168, v169
v_cvt_pk_bf16_f32 v84, v170, v171
v_cvt_pk_bf16_f32 v85, v172, v173
s_add_u32 m0, s60, 8192
s_add_u32 s93, s69, 1
s_and_b32 s93, s93, 3
s_lshl_b32 s93, s93, 16
s_add_u32 s93, s93, s79
buffer_load_dwordx4 v1, s[16:19], s93 offen offset:0  lds
v_sub_f32 v174, v174, v26
v_sub_f32 v175, v175, v26
v_sub_f32 v176, v176, v26
v_sub_f32 v177, v177, v26
v_sub_f32 v178, v178, v26
v_sub_f32 v179, v179, v26
v_sub_f32 v180, v180, v26
v_sub_f32 v181, v181, v26
v_exp_f32 v174, v174
v_exp_f32 v175, v175
v_exp_f32 v176, v176
v_exp_f32 v177, v177
v_exp_f32 v178, v178
v_exp_f32 v179, v179
v_exp_f32 v180, v180
v_exp_f32 v181, v181
v_add_f32 v30, v30, v174
v_add_f32 v31, v31, v175
v_add_f32 v32, v32, v176
v_add_f32 v33, v33, v177
v_add_f32 v30, v30, v178
v_add_f32 v31, v31, v179
v_add_f32 v32, v32, v180
v_add_f32 v33, v33, v181
v_cvt_pk_bf16_f32 v86, v174, v175
v_cvt_pk_bf16_f32 v87, v176, v177
v_cvt_pk_bf16_f32 v88, v178, v179
v_cvt_pk_bf16_f32 v89, v180, v181
v_sub_f32 v182, v182, v26
v_sub_f32 v183, v183, v26
v_sub_f32 v184, v184, v26
v_sub_f32 v185, v185, v26
v_sub_f32 v186, v186, v26
v_sub_f32 v187, v187, v26
v_sub_f32 v188, v188, v26
v_sub_f32 v189, v189, v26
v_exp_f32 v182, v182
v_exp_f32 v183, v183
v_exp_f32 v184, v184
v_exp_f32 v185, v185
v_exp_f32 v186, v186
v_exp_f32 v187, v187
v_exp_f32 v188, v188
v_exp_f32 v189, v189
v_add_f32 v30, v30, v182
v_add_f32 v31, v31, v183
v_add_f32 v32, v32, v184
v_add_f32 v33, v33, v185
v_add_f32 v30, v30, v186
v_add_f32 v31, v31, v187
v_add_f32 v32, v32, v188
v_add_f32 v33, v33, v189
v_cvt_pk_bf16_f32 v90, v182, v183
v_cvt_pk_bf16_f32 v91, v184, v185
v_cvt_pk_bf16_f32 v92, v186, v187
v_cvt_pk_bf16_f32 v93, v188, v189
buffer_load_dwordx4 v2, s[16:19], s93 offen offset:1024  lds
v_add_f32 v30, v30, v31
v_add_f32 v32, v32, v33
v_add_f32 v28, v30, v32
v_mov_b32 v30, v28
s_nop 1
v_permlane32_swap_b32 v28, v30
v_add_f32 v28, v28, v30
ds_write_b32 v254, v28 offset:1024
v_sub_f32 v190, v190, v27
v_sub_f32 v191, v191, v27
v_sub_f32 v192, v192, v27
v_sub_f32 v193, v193, v27
v_sub_f32 v194, v194, v27
v_sub_f32 v195, v195, v27
v_sub_f32 v196, v196, v27
v_sub_f32 v197, v197, v27
v_exp_f32 v190, v190
v_exp_f32 v191, v191
v_exp_f32 v192, v192
v_exp_f32 v193, v193
v_exp_f32 v194, v194
v_exp_f32 v195, v195
v_exp_f32 v196, v196
v_exp_f32 v197, v197
v_add_f32 v30, v190, v194
v_add_f32 v31, v191, v195
v_add_f32 v32, v192, v196
v_add_f32 v33, v193, v197
v_cvt_pk_bf16_f32 v94, v190, v191
v_cvt_pk_bf16_f32 v95, v192, v193
v_cvt_pk_bf16_f32 v96, v194, v195
v_cvt_pk_bf16_f32 v97, v196, v197
v_sub_f32 v198, v198, v27
v_sub_f32 v199, v199, v27
v_sub_f32 v200, v200, v27
v_sub_f32 v201, v201, v27
v_sub_f32 v202, v202, v27
v_sub_f32 v203, v203, v27
v_sub_f32 v204, v204, v27
v_sub_f32 v205, v205, v27
v_exp_f32 v198, v198
v_exp_f32 v199, v199
v_exp_f32 v200, v200
v_exp_f32 v201, v201
v_exp_f32 v202, v202
v_exp_f32 v203, v203
v_exp_f32 v204, v204
v_exp_f32 v205, v205
v_add_f32 v30, v30, v198
v_add_f32 v31, v31, v199
v_add_f32 v32, v32, v200
v_add_f32 v33, v33, v201
v_add_f32 v30, v30, v202
v_add_f32 v31, v31, v203
v_add_f32 v32, v32, v204
v_add_f32 v33, v33, v205
v_cvt_pk_bf16_f32 v98, v198, v199
v_cvt_pk_bf16_f32 v99, v200, v201
v_cvt_pk_bf16_f32 v100, v202, v203
v_cvt_pk_bf16_f32 v101, v204, v205
buffer_load_dwordx4 v3, s[16:19], s93 offen offset:2048  lds
v_sub_f32 v206, v206, v27
v_sub_f32 v207, v207, v27
v_sub_f32 v208, v208, v27
v_sub_f32 v209, v209, v27
v_sub_f32 v210, v210, v27
v_sub_f32 v211, v211, v27
v_sub_f32 v212, v212, v27
v_sub_f32 v213, v213, v27
v_exp_f32 v206, v206
v_exp_f32 v207, v207
v_exp_f32 v208, v208
v_exp_f32 v209, v209
v_exp_f32 v210, v210
v_exp_f32 v211, v211
v_exp_f32 v212, v212
v_exp_f32 v213, v213
v_add_f32 v30, v30, v206
v_add_f32 v31, v31, v207
v_add_f32 v32, v32, v208
v_add_f32 v33, v33, v209
v_add_f32 v30, v30, v210
v_add_f32 v31, v31, v211
v_add_f32 v32, v32, v212
v_add_f32 v33, v33, v213
v_cvt_pk_bf16_f32 v102, v206, v207
v_cvt_pk_bf16_f32 v103, v208, v209
v_cvt_pk_bf16_f32 v104, v210, v211
v_cvt_pk_bf16_f32 v105, v212, v213
v_sub_f32 v214, v214, v27
v_sub_f32 v215, v215, v27
v_sub_f32 v216, v216, v27
v_sub_f32 v217, v217, v27
v_sub_f32 v218, v218, v27
v_sub_f32 v219, v219, v27
v_sub_f32 v220, v220, v27
v_sub_f32 v221, v221, v27
v_exp_f32 v214, v214
v_exp_f32 v215, v215
v_exp_f32 v216, v216
v_exp_f32 v217, v217
v_exp_f32 v218, v218
v_exp_f32 v219, v219
v_exp_f32 v220, v220
v_exp_f32 v221, v221
v_add_f32 v30, v30, v214
v_add_f32 v31, v31, v215
v_add_f32 v32, v32, v216
v_add_f32 v33, v33, v217
v_add_f32 v30, v30, v218
v_add_f32 v31, v31, v219
v_add_f32 v32, v32, v220
v_add_f32 v33, v33, v221
v_cvt_pk_bf16_f32 v106, v214, v215
v_cvt_pk_bf16_f32 v107, v216, v217
v_cvt_pk_bf16_f32 v108, v218, v219
v_cvt_pk_bf16_f32 v109, v220, v221
buffer_load_dwordx4 v4, s[16:19], s93 offen offset:3072  lds
v_sub_f32 v222, v222, v27
v_sub_f32 v223, v223, v27
v_sub_f32 v224, v224, v27
v_sub_f32 v225, v225, v27
v_sub_f32 v226, v226, v27
v_sub_f32 v227, v227, v27
v_sub_f32 v228, v228, v27
v_sub_f32 v229, v229, v27
v_exp_f32 v222, v222
v_exp_f32 v223, v223
v_exp_f32 v224, v224
v_exp_f32 v225, v225
v_exp_f32 v226, v226
v_exp_f32 v227, v227
v_exp_f32 v228, v228
v_exp_f32 v229, v229
v_add_f32 v30, v30, v222
v_add_f32 v31, v31, v223
v_add_f32 v32, v32, v224
v_add_f32 v33, v33, v225
v_add_f32 v30, v30, v226
v_add_f32 v31, v31, v227
v_add_f32 v32, v32, v228
v_add_f32 v33, v33, v229
v_cvt_pk_bf16_f32 v110, v222, v223
v_cvt_pk_bf16_f32 v111, v224, v225
v_cvt_pk_bf16_f32 v112, v226, v227
v_cvt_pk_bf16_f32 v113, v228, v229
v_sub_f32 v230, v230, v27
v_sub_f32 v231, v231, v27
v_sub_f32 v232, v232, v27
v_sub_f32 v233, v233, v27
v_sub_f32 v234, v234, v27
v_sub_f32 v235, v235, v27
v_sub_f32 v236, v236, v27
v_sub_f32 v237, v237, v27
v_exp_f32 v230, v230
v_exp_f32 v231, v231
v_exp_f32 v232, v232
v_exp_f32 v233, v233
v_exp_f32 v234, v234
v_exp_f32 v235, v235
v_exp_f32 v236, v236
v_exp_f32 v237, v237
v_add_f32 v30, v30, v230
v_add_f32 v31, v31, v231
v_add_f32 v32, v32, v232
v_add_f32 v33, v33, v233
v_add_f32 v30, v30, v234
v_add_f32 v31, v31, v235
v_add_f32 v32, v32, v236
v_add_f32 v33, v33, v237
v_cvt_pk_bf16_f32 v114, v230, v231
v_cvt_pk_bf16_f32 v115, v232, v233
v_cvt_pk_bf16_f32 v116, v234, v235
v_cvt_pk_bf16_f32 v117, v236, v237
s_add_u32 m0, s60, 12288
s_add_u32 s93, s69, 1
s_and_b32 s93, s93, 3
s_lshl_b32 s93, s93, 16
s_add_u32 s93, s93, s79
s_add_u32 s93, s93, 128
buffer_load_dwordx4 v1, s[16:19], s93 offen offset:0  lds
v_sub_f32 v238, v238, v27
v_sub_f32 v239, v239, v27
v_sub_f32 v240, v240, v27
v_sub_f32 v241, v241, v27
v_sub_f32 v242, v242, v27
v_sub_f32 v243, v243, v27
v_sub_f32 v244, v244, v27
v_sub_f32 v245, v245, v27
v_exp_f32 v238, v238
v_exp_f32 v239, v239
v_exp_f32 v240, v240
v_exp_f32 v241, v241
v_exp_f32 v242, v242
v_exp_f32 v243, v243
v_exp_f32 v244, v244
v_exp_f32 v245, v245
v_add_f32 v30, v30, v238
v_add_f32 v31, v31, v239
v_add_f32 v32, v32, v240
v_add_f32 v33, v33, v241
v_add_f32 v30, v30, v242
v_add_f32 v31, v31, v243
v_add_f32 v32, v32, v244
v_add_f32 v33, v33, v245
v_cvt_pk_bf16_f32 v118, v238, v239
v_cvt_pk_bf16_f32 v119, v240, v241
v_cvt_pk_bf16_f32 v120, v242, v243
v_cvt_pk_bf16_f32 v121, v244, v245
v_sub_f32 v246, v246, v27
v_sub_f32 v247, v247, v27
v_sub_f32 v248, v248, v27
v_sub_f32 v249, v249, v27
v_sub_f32 v250, v250, v27
v_sub_f32 v251, v251, v27
v_sub_f32 v252, v252, v27
v_sub_f32 v253, v253, v27
v_exp_f32 v246, v246
v_exp_f32 v247, v247
v_exp_f32 v248, v248
v_exp_f32 v249, v249
v_exp_f32 v250, v250
v_exp_f32 v251, v251
v_exp_f32 v252, v252
v_exp_f32 v253, v253
v_add_f32 v30, v30, v246
v_add_f32 v31, v31, v247
v_add_f32 v32, v32, v248
v_add_f32 v33, v33, v249
v_add_f32 v30, v30, v250
v_add_f32 v31, v31, v251
v_add_f32 v32, v32, v252
v_add_f32 v33, v33, v253
v_cvt_pk_bf16_f32 v122, v246, v247
v_cvt_pk_bf16_f32 v123, v248, v249
v_cvt_pk_bf16_f32 v124, v250, v251
v_cvt_pk_bf16_f32 v125, v252, v253
buffer_load_dwordx4 v2, s[16:19], s93 offen offset:1024  lds
v_add_f32 v30, v30, v31
v_add_f32 v32, v32, v33
v_add_f32 v29, v30, v32
v_mov_b32 v30, v29
s_nop 1
v_permlane32_swap_b32 v29, v30
v_add_f32 v29, v29, v30
ds_write_b32 v254, v29 offset:3072
s_waitcnt vmcnt(10)
ds_read_b64_tr_b16 v[30:31], v17 offset:0
ds_read_b64_tr_b16 v[32:33], v18 offset:0
ds_read_b64_tr_b16 v[34:35], v19 offset:0
ds_read_b64_tr_b16 v[36:37], v20 offset:0
ds_read_b64_tr_b16 v[38:39], v17 offset:2048
ds_read_b64_tr_b16 v[40:41], v18 offset:2048
ds_read_b64_tr_b16 v[42:43], v19 offset:2048
ds_read_b64_tr_b16 v[44:45], v20 offset:2048
s_waitcnt vmcnt(6)
s_waitcnt lgkmcnt(0)
v_mfma_f32_32x32x16_bf16 v[126:141], v[30:33], v[62:65], 0
ds_read_b64_tr_b16 v[46:47], v17 offset:4096
v_mfma_f32_32x32x16_bf16 v[190:205], v[30:33], v[94:97], 0
ds_read_b64_tr_b16 v[48:49], v18 offset:4096
v_mfma_f32_32x32x16_bf16 v[142:157], v[34:37], v[62:65], 0
ds_read_b64_tr_b16 v[50:51], v19 offset:4096
v_mfma_f32_32x32x16_bf16 v[206:221], v[34:37], v[94:97], 0
ds_read_b64_tr_b16 v[52:53], v20 offset:4096
v_mfma_f32_32x32x16_bf16 v[126:141], v[38:41], v[66:69], v[126:141]
ds_read_b64_tr_b16 v[54:55], v17 offset:6144
v_mfma_f32_32x32x16_bf16 v[190:205], v[38:41], v[98:101], v[190:205]
ds_read_b64_tr_b16 v[56:57], v18 offset:6144
v_mfma_f32_32x32x16_bf16 v[142:157], v[42:45], v[66:69], v[142:157]
ds_read_b64_tr_b16 v[58:59], v19 offset:6144
v_mfma_f32_32x32x16_bf16 v[206:221], v[42:45], v[98:101], v[206:221]
ds_read_b64_tr_b16 v[60:61], v20 offset:6144
s_waitcnt vmcnt(2)
s_waitcnt lgkmcnt(0)
v_mfma_f32_32x32x16_bf16 v[158:173], v[46:49], v[62:65], 0
ds_read_b64_tr_b16 v[30:31], v17 offset:8192
v_mfma_f32_32x32x16_bf16 v[222:237], v[46:49], v[94:97], 0
ds_read_b64_tr_b16 v[32:33], v18 offset:8192
v_mfma_f32_32x32x16_bf16 v[174:189], v[50:53], v[62:65], 0
buffer_load_dwordx4 v3, s[16:19], s93 offen offset:2048  lds
v_mfma_f32_32x32x16_bf16 v[238:253], v[50:53], v[94:97], 0
ds_read_b64_tr_b16 v[34:35], v19 offset:8192
ds_read_b64_tr_b16 v[36:37], v20 offset:8192
v_mfma_f32_32x32x16_bf16 v[158:173], v[54:57], v[66:69], v[158:173]
buffer_load_dwordx4 v4, s[16:19], s93 offen offset:3072  lds
v_mfma_f32_32x32x16_bf16 v[222:237], v[54:57], v[98:101], v[222:237]
ds_read_b64_tr_b16 v[38:39], v17 offset:10240
v_mfma_f32_32x32x16_bf16 v[174:189], v[58:61], v[66:69], v[174:189]
ds_read_b64_tr_b16 v[40:41], v18 offset:10240
v_mfma_f32_32x32x16_bf16 v[238:253], v[58:61], v[98:101], v[238:253]
ds_read_b64_tr_b16 v[42:43], v19 offset:10240
ds_read_b64_tr_b16 v[44:45], v20 offset:10240
s_waitcnt vmcnt(0)
s_waitcnt lgkmcnt(0)
v_mfma_f32_32x32x16_bf16 v[126:141], v[30:33], v[70:73], v[126:141]
ds_read_b64_tr_b16 v[46:47], v17 offset:12288
v_mfma_f32_32x32x16_bf16 v[190:205], v[30:33], v[102:105], v[190:205]
ds_read_b64_tr_b16 v[48:49], v18 offset:12288
s_add_u32 m0, s60, 0
s_add_u32 s93, s69, 2
s_and_b32 s93, s93, 3
s_lshl_b32 s93, s93, 16
s_add_u32 s93, s93, s79
buffer_load_dwordx4 v1, s[16:19], s93 offen offset:0  lds
v_mfma_f32_32x32x16_bf16 v[142:157], v[34:37], v[70:73], v[142:157]
ds_read_b64_tr_b16 v[50:51], v19 offset:12288
v_mfma_f32_32x32x16_bf16 v[206:221], v[34:37], v[102:105], v[206:221]
ds_read_b64_tr_b16 v[52:53], v20 offset:12288
buffer_load_dwordx4 v2, s[16:19], s93 offen offset:1024  lds
v_mfma_f32_32x32x16_bf16 v[126:141], v[38:41], v[74:77], v[126:141]
ds_read_b64_tr_b16 v[54:55], v17 offset:14336
v_mfma_f32_32x32x16_bf16 v[190:205], v[38:41], v[106:109], v[190:205]
ds_read_b64_tr_b16 v[56:57], v18 offset:14336
buffer_load_dwordx4 v3, s[16:19], s93 offen offset:2048  lds
v_mfma_f32_32x32x16_bf16 v[142:157], v[42:45], v[74:77], v[142:157]
ds_read_b64_tr_b16 v[58:59], v19 offset:14336
v_mfma_f32_32x32x16_bf16 v[206:221], v[42:45], v[106:109], v[206:221]
ds_read_b64_tr_b16 v[60:61], v20 offset:14336
buffer_load_dwordx4 v4, s[16:19], s93 offen offset:3072  lds
s_waitcnt vmcnt(0)
s_waitcnt lgkmcnt(0)
v_mfma_f32_32x32x16_bf16 v[158:173], v[46:49], v[70:73], v[158:173]
ds_read_b64_tr_b16 v[30:31], v17 offset:0
v_mfma_f32_32x32x16_bf16 v[222:237], v[46:49], v[102:105], v[222:237]
ds_read_b64_tr_b16 v[32:33], v18 offset:0
s_add_u32 m0, s60, 4096
s_add_u32 s93, s69, 2
s_and_b32 s93, s93, 3
s_lshl_b32 s93, s93, 16
s_add_u32 s93, s93, s79
s_add_u32 s93, s93, 128
buffer_load_dwordx4 v1, s[16:19], s93 offen offset:0  lds
v_mfma_f32_32x32x16_bf16 v[174:189], v[50:53], v[70:73], v[174:189]
ds_read_b64_tr_b16 v[34:35], v19 offset:0
v_mfma_f32_32x32x16_bf16 v[238:253], v[50:53], v[102:105], v[238:253]
ds_read_b64_tr_b16 v[36:37], v20 offset:0
buffer_load_dwordx4 v2, s[16:19], s93 offen offset:1024  lds
v_mfma_f32_32x32x16_bf16 v[158:173], v[54:57], v[74:77], v[158:173]
ds_read_b64_tr_b16 v[38:39], v17 offset:2048
v_mfma_f32_32x32x16_bf16 v[222:237], v[54:57], v[106:109], v[222:237]
ds_read_b64_tr_b16 v[40:41], v18 offset:2048
buffer_load_dwordx4 v3, s[16:19], s93 offen offset:2048  lds
v_mfma_f32_32x32x16_bf16 v[174:189], v[58:61], v[74:77], v[174:189]
ds_read_b64_tr_b16 v[42:43], v19 offset:2048
v_mfma_f32_32x32x16_bf16 v[238:253], v[58:61], v[106:109], v[238:253]
ds_read_b64_tr_b16 v[44:45], v20 offset:2048
buffer_load_dwordx4 v4, s[16:19], s93 offen offset:3072  lds
s_waitcnt vmcnt(0)
s_waitcnt lgkmcnt(0)
v_mfma_f32_32x32x16_bf16 v[126:141], v[30:33], v[78:81], v[126:141]
ds_read_b64_tr_b16 v[46:47], v17 offset:4096
v_mfma_f32_32x32x16_bf16 v[190:205], v[30:33], v[110:113], v[190:205]
ds_read_b64_tr_b16 v[48:49], v18 offset:4096
s_add_u32 m0, s60, 8192
s_add_u32 s93, s69, 3
s_and_b32 s93, s93, 3
s_lshl_b32 s93, s93, 16
s_add_u32 s93, s93, s79
buffer_load_dwordx4 v1, s[16:19], s93 offen offset:0  lds
v_mfma_f32_32x32x16_bf16 v[142:157], v[34:37], v[78:81], v[142:157]
ds_read_b64_tr_b16 v[50:51], v19 offset:4096
v_mfma_f32_32x32x16_bf16 v[206:221], v[34:37], v[110:113], v[206:221]
ds_read_b64_tr_b16 v[52:53], v20 offset:4096
buffer_load_dwordx4 v2, s[16:19], s93 offen offset:1024  lds
v_mfma_f32_32x32x16_bf16 v[126:141], v[38:41], v[82:85], v[126:141]
ds_read_b64_tr_b16 v[54:55], v17 offset:6144
v_mfma_f32_32x32x16_bf16 v[190:205], v[38:41], v[114:117], v[190:205]
ds_read_b64_tr_b16 v[56:57], v18 offset:6144
buffer_load_dwordx4 v3, s[16:19], s93 offen offset:2048  lds
v_mfma_f32_32x32x16_bf16 v[142:157], v[42:45], v[82:85], v[142:157]
ds_read_b64_tr_b16 v[58:59], v19 offset:6144
v_mfma_f32_32x32x16_bf16 v[206:221], v[42:45], v[114:117], v[206:221]
ds_read_b64_tr_b16 v[60:61], v20 offset:6144
buffer_load_dwordx4 v4, s[16:19], s93 offen offset:3072  lds
s_waitcnt vmcnt(0)
s_waitcnt lgkmcnt(0)
v_mfma_f32_32x32x16_bf16 v[158:173], v[46:49], v[78:81], v[158:173]
ds_read_b64_tr_b16 v[30:31], v17 offset:8192
v_mfma_f32_32x32x16_bf16 v[222:237], v[46:49], v[110:113], v[222:237]
ds_read_b64_tr_b16 v[32:33], v18 offset:8192
s_add_u32 m0, s60, 12288
s_add_u32 s93, s69, 3
s_and_b32 s93, s93, 3
s_lshl_b32 s93, s93, 16
s_add_u32 s93, s93, s79
s_add_u32 s93, s93, 128
buffer_load_dwordx4 v1, s[16:19], s93 offen offset:0  lds
v_mfma_f32_32x32x16_bf16 v[174:189], v[50:53], v[78:81], v[174:189]
ds_read_b64_tr_b16 v[34:35], v19 offset:8192
v_mfma_f32_32x32x16_bf16 v[238:253], v[50:53], v[110:113], v[238:253]
ds_read_b64_tr_b16 v[36:37], v20 offset:8192
buffer_load_dwordx4 v2, s[16:19], s93 offen offset:1024  lds
v_mfma_f32_32x32x16_bf16 v[158:173], v[54:57], v[82:85], v[158:173]
ds_read_b64_tr_b16 v[38:39], v17 offset:10240
v_mfma_f32_32x32x16_bf16 v[222:237], v[54:57], v[114:117], v[222:237]
ds_read_b64_tr_b16 v[40:41], v18 offset:10240
buffer_load_dwordx4 v3, s[16:19], s93 offen offset:2048  lds
v_mfma_f32_32x32x16_bf16 v[174:189], v[58:61], v[82:85], v[174:189]
ds_read_b64_tr_b16 v[42:43], v19 offset:10240
v_mfma_f32_32x32x16_bf16 v[238:253], v[58:61], v[114:117], v[238:253]
ds_read_b64_tr_b16 v[44:45], v20 offset:10240
buffer_load_dwordx4 v4, s[16:19], s93 offen offset:3072  lds
s_waitcnt vmcnt(0)
s_waitcnt lgkmcnt(0)
v_mfma_f32_32x32x16_bf16 v[126:141], v[30:33], v[86:89], v[126:141]
ds_read_b64_tr_b16 v[46:47], v17 offset:12288
v_mfma_f32_32x32x16_bf16 v[190:205], v[30:33], v[118:121], v[190:205]
ds_read_b64_tr_b16 v[48:49], v18 offset:12288
v_mfma_f32_32x32x16_bf16 v[142:157], v[34:37], v[86:89], v[142:157]
ds_read_b64_tr_b16 v[50:51], v19 offset:12288
v_mfma_f32_32x32x16_bf16 v[206:221], v[34:37], v[118:121], v[206:221]
ds_read_b64_tr_b16 v[52:53], v20 offset:12288
v_mfma_f32_32x32x16_bf16 v[126:141], v[38:41], v[90:93], v[126:141]
ds_read_b64_tr_b16 v[54:55], v17 offset:14336
v_mfma_f32_32x32x16_bf16 v[190:205], v[38:41], v[122:125], v[190:205]
ds_read_b64_tr_b16 v[56:57], v18 offset:14336
v_mfma_f32_32x32x16_bf16 v[142:157], v[42:45], v[90:93], v[142:157]
ds_read_b64_tr_b16 v[58:59], v19 offset:14336
v_mfma_f32_32x32x16_bf16 v[206:221], v[42:45], v[122:125], v[206:221]
ds_read_b64_tr_b16 v[60:61], v20 offset:14336
s_waitcnt lgkmcnt(0)
v_mfma_f32_32x32x16_bf16 v[158:173], v[46:49], v[86:89], v[158:173]
v_mfma_f32_32x32x16_bf16 v[222:237], v[46:49], v[118:121], v[222:237]
v_mfma_f32_32x32x16_bf16 v[174:189], v[50:53], v[86:89], v[174:189]
v_mfma_f32_32x32x16_bf16 v[238:253], v[50:53], v[118:121], v[238:253]
v_mfma_f32_32x32x16_bf16 v[158:173], v[54:57], v[90:93], v[158:173]
v_mfma_f32_32x32x16_bf16 v[222:237], v[54:57], v[122:125], v[222:237]
v_mfma_f32_32x32x16_bf16 v[174:189], v[58:61], v[90:93], v[174:189]
v_mfma_f32_32x32x16_bf16 v[238:253], v[58:61], v[122:125], v[238:253]
v_and_b32 v12, 7, v0
v_lshlrev_b32 v12, 2, v12
v_bfe_u32 v254, v0, 3, 1
v_lshl_add_u32 v12, v254, 7, v12
buffer_load_dword v10, v12, s[56:59], s83 offen sc1
v_add_u32 v38, s60, v25
s_lshl_b32 s61, s3, 10
v_add_u32 v39, s61, v25
v_add_u32 v40, 0x10000, v39
v_and_b32 v41, 31, v0
v_lshlrev_b32 v41, 5, v41
v_add_u32 v41, 148480, v41
v_bfe_u32 v254, v0, 2, 1
v_lshrrev_b32 v255, 5, v0
v_xor_b32 v254, v254, v255
v_bfe_u32 v255, v0, 4, 1
v_or_b32 v254, v254, v255
v_lshlrev_b32 v254, 2, v254
v_bfe_u32 v255, v0, 3, 1
v_lshl_add_u32 v254, v255, 1, v254
v_bfe_u32 v255, v0, 1, 1
v_add_u32 v254, v254, v255
v_and_b32 v255, 1, v0
v_lshlrev_b32 v255, 4, v255
v_mov_b32 v30, 0x3f80
v_lshlrev_b32 v255, v255, v30
v_cmp_eq_u32 vcc, 0, v254
s_nop 1
v_cndmask_b32 v30, 0, v255, vcc
v_cmp_eq_u32 vcc, 1, v254
s_nop 1
v_cndmask_b32 v31, 0, v255, vcc
v_cmp_eq_u32 vcc, 2, v254
s_nop 1
v_cndmask_b32 v32, 0, v255, vcc
v_cmp_eq_u32 vcc, 3, v254
s_nop 1
v_cndmask_b32 v33, 0, v255, vcc
v_cvt_pk_bf16_f32 v62, v126, v127
v_cvt_pk_bf16_f32 v63, v128, v129
v_cvt_pk_bf16_f32 v64, v130, v131
v_cvt_pk_bf16_f32 v65, v132, v133
v_cvt_pk_bf16_f32 v66, v134, v135
v_cvt_pk_bf16_f32 v67, v136, v137
v_cvt_pk_bf16_f32 v68, v138, v139
v_cvt_pk_bf16_f32 v69, v140, v141
v_cvt_pk_bf16_f32 v70, v142, v143
v_cvt_pk_bf16_f32 v71, v144, v145
v_cvt_pk_bf16_f32 v72, v146, v147
v_cvt_pk_bf16_f32 v73, v148, v149
v_cvt_pk_bf16_f32 v74, v150, v151
v_cvt_pk_bf16_f32 v75, v152, v153
v_cvt_pk_bf16_f32 v76, v154, v155
v_cvt_pk_bf16_f32 v77, v156, v157
v_cvt_pk_bf16_f32 v78, v158, v159
v_cvt_pk_bf16_f32 v79, v160, v161
v_cvt_pk_bf16_f32 v80, v162, v163
v_cvt_pk_bf16_f32 v81, v164, v165
v_cvt_pk_bf16_f32 v82, v166, v167
v_cvt_pk_bf16_f32 v83, v168, v169
v_cvt_pk_bf16_f32 v84, v170, v171
v_cvt_pk_bf16_f32 v85, v172, v173
v_cvt_pk_bf16_f32 v86, v174, v175
v_cvt_pk_bf16_f32 v87, v176, v177
v_cvt_pk_bf16_f32 v88, v178, v179
v_cvt_pk_bf16_f32 v89, v180, v181
v_cvt_pk_bf16_f32 v90, v182, v183
v_cvt_pk_bf16_f32 v91, v184, v185
v_cvt_pk_bf16_f32 v92, v186, v187
v_cvt_pk_bf16_f32 v93, v188, v189
ds_write_b128 v38, v[62:65] offset:0
ds_write_b128 v38, v[66:69] offset:1024
ds_write_b128 v38, v[70:73] offset:2048
ds_write_b128 v38, v[74:77] offset:3072
ds_write_b128 v38, v[78:81] offset:4096
ds_write_b128 v38, v[82:85] offset:5120
ds_write_b128 v38, v[86:89] offset:6144
ds_write_b128 v38, v[90:93] offset:7168
s_waitcnt lgkmcnt(6)
v_cvt_pk_bf16_f32 v94, v190, v191
v_cvt_pk_bf16_f32 v95, v192, v193
v_cvt_pk_bf16_f32 v96, v194, v195
v_cvt_pk_bf16_f32 v97, v196, v197
v_cvt_pk_bf16_f32 v98, v198, v199
v_cvt_pk_bf16_f32 v99, v200, v201
v_cvt_pk_bf16_f32 v100, v202, v203
v_cvt_pk_bf16_f32 v101, v204, v205
v_cvt_pk_bf16_f32 v102, v206, v207
v_cvt_pk_bf16_f32 v103, v208, v209
v_cvt_pk_bf16_f32 v104, v210, v211
v_cvt_pk_bf16_f32 v105, v212, v213
v_cvt_pk_bf16_f32 v106, v214, v215
v_cvt_pk_bf16_f32 v107, v216, v217
v_cvt_pk_bf16_f32 v108, v218, v219
v_cvt_pk_bf16_f32 v109, v220, v221
v_cvt_pk_bf16_f32 v110, v222, v223
v_cvt_pk_bf16_f32 v111, v224, v225
v_cvt_pk_bf16_f32 v112, v226, v227
v_cvt_pk_bf16_f32 v113, v228, v229
v_cvt_pk_bf16_f32 v114, v230, v231
v_cvt_pk_bf16_f32 v115, v232, v233
v_cvt_pk_bf16_f32 v116, v234, v235
v_cvt_pk_bf16_f32 v117, v236, v237
v_cvt_pk_bf16_f32 v118, v238, v239
v_cvt_pk_bf16_f32 v119, v240, v241
v_cvt_pk_bf16_f32 v120, v242, v243
v_cvt_pk_bf16_f32 v121, v244, v245
v_cvt_pk_bf16_f32 v122, v246, v247
v_cvt_pk_bf16_f32 v123, v248, v249
v_cvt_pk_bf16_f32 v124, v250, v251
v_cvt_pk_bf16_f32 v125, v252, v253
ds_write_b128 v38, v[94:97] offset:8192
ds_write_b128 v38, v[98:101] offset:9216
ds_write_b128 v38, v[102:105] offset:10240
ds_write_b128 v38, v[106:109] offset:11264
ds_write_b128 v38, v[110:113] offset:12288
ds_write_b128 v38, v[114:117] offset:13312
ds_write_b128 v38, v[118:121] offset:14336
ds_write_b128 v38, v[122:125] offset:15360
s_waitcnt lgkmcnt(0)
s_barrier
ds_read_b128 v[174:177], v41 offset:0
ds_read_b128 v[178:181], v41 offset:16
ds_read_b128 v[126:129], v39 offset:0
ds_read_b128 v[130:133], v39 offset:16384
ds_read_b128 v[134:137], v39 offset:32768
ds_read_b128 v[138:141], v39 offset:49152
ds_read_b128 v[142:145], v40 offset:0
ds_read_b128 v[146:149], v40 offset:16384
ds_read_b128 v[150:153], v40 offset:32768
ds_read_b128 v[154:157], v40 offset:49152
s_waitcnt lgkmcnt(8)
v_add_f32 v174, v174, v175
v_add_f32 v176, v176, v177
v_add_f32 v178, v178, v179
v_add_f32 v180, v180, v181
v_add_f32 v174, v174, v176
v_add_f32 v178, v178, v180
v_add_f32 v174, v174, v178
v_rcp_f32 v174, v174
s_waitcnt lgkmcnt(7)
v_mfma_f32_32x32x16_bf16 v[158:173], v[30:33], v[126:129], 0
s_waitcnt lgkmcnt(6)
v_mfma_f32_32x32x16_bf16 v[158:173], v[30:33], v[130:133], v[158:173]
s_waitcnt lgkmcnt(5)
v_mfma_f32_32x32x16_bf16 v[158:173], v[30:33], v[134:137], v[158:173]
s_waitcnt lgkmcnt(4)
v_mfma_f32_32x32x16_bf16 v[158:173], v[30:33], v[138:141], v[158:173]
s_waitcnt lgkmcnt(3)
v_mfma_f32_32x32x16_bf16 v[158:173], v[30:33], v[142:145], v[158:173]
s_waitcnt lgkmcnt(2)
v_mfma_f32_32x32x16_bf16 v[158:173], v[30:33], v[146:149], v[158:173]
s_waitcnt lgkmcnt(1)
v_mfma_f32_32x32x16_bf16 v[158:173], v[30:33], v[150:153], v[158:173]
s_waitcnt lgkmcnt(0)
v_mfma_f32_32x32x16_bf16 v[158:173], v[30:33], v[154:157], v[158:173]
ds_read_b128 v[238:241], v41 offset:2048
ds_read_b128 v[242:245], v41 offset:2064
ds_read_b128 v[190:193], v39 offset:8192
ds_read_b128 v[194:197], v39 offset:24576
ds_read_b128 v[198:201], v39 offset:40960
ds_read_b128 v[202:205], v39 offset:57344
ds_read_b128 v[206:209], v40 offset:8192
ds_read_b128 v[210:213], v40 offset:24576
ds_read_b128 v[214:217], v40 offset:40960
ds_read_b128 v[218:221], v40 offset:57344
s_waitcnt lgkmcnt(8)
v_add_f32 v238, v238, v239
v_add_f32 v240, v240, v241
v_add_f32 v242, v242, v243
v_add_f32 v244, v244, v245
v_add_f32 v238, v238, v240
v_add_f32 v242, v242, v244
v_add_f32 v238, v238, v242
v_rcp_f32 v238, v238
s_waitcnt lgkmcnt(7)
v_mfma_f32_32x32x16_bf16 v[222:237], v[30:33], v[190:193], 0
s_waitcnt lgkmcnt(6)
v_mfma_f32_32x32x16_bf16 v[222:237], v[30:33], v[194:197], v[222:237]
s_waitcnt lgkmcnt(5)
v_mfma_f32_32x32x16_bf16 v[222:237], v[30:33], v[198:201], v[222:237]
s_waitcnt lgkmcnt(4)
v_mfma_f32_32x32x16_bf16 v[222:237], v[30:33], v[202:205], v[222:237]
s_waitcnt lgkmcnt(3)
v_mfma_f32_32x32x16_bf16 v[222:237], v[30:33], v[206:209], v[222:237]
s_waitcnt lgkmcnt(2)
v_mfma_f32_32x32x16_bf16 v[222:237], v[30:33], v[210:213], v[222:237]
s_waitcnt lgkmcnt(1)
v_mfma_f32_32x32x16_bf16 v[222:237], v[30:33], v[214:217], v[222:237]
s_waitcnt lgkmcnt(0)
v_mfma_f32_32x32x16_bf16 v[222:237], v[30:33], v[218:221], v[222:237]
v_mul_f32 v158, v174, v158
v_mul_f32 v159, v174, v159
v_mul_f32 v160, v174, v160
v_mul_f32 v161, v174, v161
v_mul_f32 v162, v174, v162
v_mul_f32 v163, v174, v163
v_mul_f32 v164, v174, v164
v_mul_f32 v165, v174, v165
v_cvt_pk_bf16_f32 v166, v158, v159
v_cvt_pk_bf16_f32 v167, v160, v161
v_cvt_pk_bf16_f32 v168, v162, v163
v_cvt_pk_bf16_f32 v169, v164, v165
buffer_store_dwordx4 v[166:169], v39, s[56:59], s71 offen sc1
v_mul_f32 v222, v238, v222
v_mul_f32 v223, v238, v223
v_mul_f32 v224, v238, v224
v_mul_f32 v225, v238, v225
v_mul_f32 v226, v238, v226
v_mul_f32 v227, v238, v227
v_mul_f32 v228, v238, v228
v_mul_f32 v229, v238, v229
v_cvt_pk_bf16_f32 v230, v222, v223
v_cvt_pk_bf16_f32 v231, v224, v225
v_cvt_pk_bf16_f32 v232, v226, v227
v_cvt_pk_bf16_f32 v233, v228, v229
s_add_u32 s61, s71, 8192
buffer_store_dwordx4 v[230:233], v39, s[56:59], s61 offen sc1
s_barrier
s_waitcnt vmcnt(0)
v_mov_b32 v254, 1
s_mov_b64 exec, 1
buffer_store_dword v254, off, s[56:59], s72 offset:0 sc1
buffer_store_dword v254, off, s[56:59], s72 offset:128 sc1
s_mov_b64 exec, -1
s_add_u32 m0, s60, 0
s_add_u32 s93, s68, 0
s_and_b32 s93, s93, 7
s_lshl_b32 s93, s93, 16
s_add_u32 s93, s93, s70
buffer_load_dwordx4 v5, s[44:47], s93 offen offset:0  lds
buffer_load_dwordx4 v6, s[44:47], s93 offen offset:1024  lds
buffer_load_dwordx4 v7, s[44:47], s93 offen offset:2048  lds
buffer_load_dwordx4 v8, s[44:47], s93 offen offset:3072  lds
s_mov_b32 s62, 0
s_nop 4
L_chk_21:
v_cmp_ne_u32 vcc, 1, v10
s_add_u32 s62, s62, 1
s_nop 2
s_cbranch_vccz L_ok_22
s_cmp_lt_u32 s62, 200000
s_cbranch_scc0 L_ok_22
s_sleep 8
buffer_load_dword v10, v12, s[56:59], s83 offen sc1
s_waitcnt vmcnt(0)
s_branch L_chk_21
L_ok_22:
s_waitcnt vmcnt(0)
ds_read_b64_tr_b16 v[30:31], v17 offset:0
ds_read_b64_tr_b16 v[32:33], v18 offset:0
ds_read_b64_tr_b16 v[34:35], v19 offset:0
ds_read_b64_tr_b16 v[36:37], v20 offset:0
ds_read_b64_tr_b16 v[38:39], v17 offset:2048
ds_read_b64_tr_b16 v[40:41], v18 offset:2048
ds_read_b64_tr_b16 v[42:43], v19 offset:2048
ds_read_b64_tr_b16 v[44:45], v20 offset:2048
s_add_u32 m0, s60, 4096
s_add_u32 s93, s68, 1
s_and_b32 s93, s93, 7
s_lshl_b32 s93, s93, 16
s_add_u32 s93, s93, s70
buffer_load_dwordx4 v5, s[44:47], s93 offen offset:0  lds
buffer_load_dwordx4 v6, s[44:47], s93 offen offset:1024  lds
buffer_load_dwordx4 v7, s[44:47], s93 offen offset:2048  lds
buffer_load_dwordx4 v8, s[44:47], s93 offen offset:3072  lds
s_waitcnt vmcnt(0)
s_add_u32 m0, s60, 8192
s_add_u32 s93, s68, 2
s_and_b32 s93, s93, 7
s_lshl_b32 s93, s93, 16
s_add_u32 s93, s93, s70
buffer_load_dwordx4 v5, s[44:47], s93 offen offset:0  lds
buffer_load_dwordx4 v6, s[44:47], s93 offen offset:1024  lds
buffer_load_dwordx4 v7, s[44:47], s93 offen offset:2048  lds
buffer_load_dwordx4 v8, s[44:47], s93 offen offset:3072  lds
s_add_u32 m0, s60, 12288
s_add_u32 s93, s68, 3
s_and_b32 s93, s93, 7
s_lshl_b32 s93, s93, 16
s_add_u32 s93, s93, s70
buffer_load_dwordx4 v5, s[44:47], s93 offen offset:0  lds
buffer_load_dwordx4 v6, s[44:47], s93 offen offset:1024  lds
s_waitcnt vmcnt(5)
buffer_load_dwordx4 v7, s[44:47], s93 offen offset:2048  lds
s_waitcnt vmcnt(5)
buffer_load_dwordx4 v8, s[44:47], s93 offen offset:3072  lds
s_waitcnt vmcnt(5)
s_add_u32 s89, s68, 0
s_and_b32 s89, s89, 7
s_lshl_b32 s89, s89, 11
s_add_u32 s89, s89, s82
buffer_load_dwordx4 v[126:129], v25, s[56:59], s89 offen offset:0 sc1
s_waitcnt vmcnt(5)
buffer_load_dwordx4 v[130:133], v25, s[56:59], s89 offen offset:1024 sc1
s_waitcnt vmcnt(5)
s_add_u32 s89, s68, 1
s_and_b32 s89, s89, 7
s_lshl_b32 s89, s89, 11
s_add_u32 s89, s89, s82
buffer_load_dwordx4 v[134:137], v25, s[56:59], s89 offen offset:0 sc1
s_waitcnt vmcnt(5)
buffer_load_dwordx4 v[138:141], v25, s[56:59], s89 offen offset:1024 sc1
s_waitcnt vmcnt(5)
s_add_u32 s89, s68, 2
s_and_b32 s89, s89, 7
s_lshl_b32 s89, s89, 11
s_add_u32 s89, s89, s82
buffer_load_dwordx4 v[142:145], v25, s[56:59], s89 offen offset:0 sc1
s_waitcnt vmcnt(5)
buffer_load_dwordx4 v[146:149], v25, s[56:59], s89 offen offset:1024 sc1
s_waitcnt vmcnt(5)
s_add_u32 s89, s68, 3
s_and_b32 s89, s89, 7
s_lshl_b32 s89, s89, 11
s_add_u32 s89, s89, s82
buffer_load_dwordx4 v[150:153], v25, s[56:59], s89 offen offset:0 sc1
s_waitcnt vmcnt(5)
buffer_load_dwordx4 v[154:157], v25, s[56:59], s89 offen offset:1024 sc1
s_waitcnt lgkmcnt(0)
v_mfma_f32_32x32x16_bf16 v[62:77], v[30:33], v[126:129], 0
ds_read_b64_tr_b16 v[46:47], v17 offset:4096
ds_read_b64_tr_b16 v[48:49], v18 offset:4096
v_mfma_f32_32x32x16_bf16 v[78:93], v[34:37], v[126:129], 0
s_add_u32 s89, s68, 4
s_and_b32 s89, s89, 7
s_lshl_b32 s89, s89, 11
s_add_u32 s89, s89, s82
buffer_load_dwordx4 v[158:161], v25, s[56:59], s89 offen offset:0 sc1
ds_read_b64_tr_b16 v[50:51], v19 offset:4096
ds_read_b64_tr_b16 v[52:53], v20 offset:4096
v_mfma_f32_32x32x16_bf16 v[62:77], v[38:41], v[130:133], v[62:77]
buffer_load_dwordx4 v[162:165], v25, s[56:59], s89 offen offset:1024 sc1
ds_read_b64_tr_b16 v[54:55], v17 offset:6144
v_mfma_f32_32x32x16_bf16 v[78:93], v[42:45], v[130:133], v[78:93]
ds_read_b64_tr_b16 v[56:57], v18 offset:6144
ds_read_b64_tr_b16 v[58:59], v19 offset:6144
ds_read_b64_tr_b16 v[60:61], v20 offset:6144
s_waitcnt vmcnt(5)
s_add_u32 s89, s68, 5
s_and_b32 s89, s89, 7
s_lshl_b32 s89, s89, 11
s_add_u32 s89, s89, s82
buffer_load_dwordx4 v[166:169], v25, s[56:59], s89 offen offset:0 sc1
s_waitcnt lgkmcnt(0)
v_mfma_f32_32x32x16_bf16 v[62:77], v[46:49], v[134:137], v[62:77]
ds_read_b64_tr_b16 v[30:31], v17 offset:8192
ds_read_b64_tr_b16 v[32:33], v18 offset:8192
v_mfma_f32_32x32x16_bf16 v[78:93], v[50:53], v[134:137], v[78:93]
buffer_load_dwordx4 v[170:173], v25, s[56:59], s89 offen offset:1024 sc1
ds_read_b64_tr_b16 v[34:35], v19 offset:8192
ds_read_b64_tr_b16 v[36:37], v20 offset:8192
v_mfma_f32_32x32x16_bf16 v[62:77], v[54:57], v[138:141], v[62:77]
s_add_u32 s89, s68, 6
s_and_b32 s89, s89, 7
s_lshl_b32 s89, s89, 11
s_add_u32 s89, s89, s82
buffer_load_dwordx4 v[174:177], v25, s[56:59], s89 offen offset:0 sc1
ds_read_b64_tr_b16 v[38:39], v17 offset:10240
v_mfma_f32_32x32x16_bf16 v[78:93], v[58:61], v[138:141], v[78:93]
ds_read_b64_tr_b16 v[40:41], v18 offset:10240
ds_read_b64_tr_b16 v[42:43], v19 offset:10240
ds_read_b64_tr_b16 v[44:45], v20 offset:10240
s_waitcnt vmcnt(5)
buffer_load_dwordx4 v[178:181], v25, s[56:59], s89 offen offset:1024 sc1
s_waitcnt lgkmcnt(0)
v_mfma_f32_32x32x16_bf16 v[62:77], v[30:33], v[142:145], v[62:77]
ds_read_b64_tr_b16 v[46:47], v17 offset:12288
ds_read_b64_tr_b16 v[48:49], v18 offset:12288
v_mfma_f32_32x32x16_bf16 v[78:93], v[34:37], v[142:145], v[78:93]
s_add_u32 s89, s68, 7
s_and_b32 s89, s89, 7
s_lshl_b32 s89, s89, 11
s_add_u32 s89, s89, s82
buffer_load_dwordx4 v[182:185], v25, s[56:59], s89 offen offset:0 sc1
ds_read_b64_tr_b16 v[50:51], v19 offset:12288
ds_read_b64_tr_b16 v[52:53], v20 offset:12288
v_mfma_f32_32x32x16_bf16 v[62:77], v[38:41], v[146:149], v[62:77]
buffer_load_dwordx4 v[186:189], v25, s[56:59], s89 offen offset:1024 sc1
ds_read_b64_tr_b16 v[54:55], v17 offset:14336
v_mfma_f32_32x32x16_bf16 v[78:93], v[42:45], v[146:149], v[78:93]
ds_read_b64_tr_b16 v[56:57], v18 offset:14336
ds_read_b64_tr_b16 v[58:59], v19 offset:14336
ds_read_b64_tr_b16 v[60:61], v20 offset:14336
s_add_u32 m0, s60, 0
s_add_u32 s93, s68, 4
s_and_b32 s93, s93, 7
s_lshl_b32 s93, s93, 16
s_add_u32 s93, s93, s70
s_waitcnt vmcnt(5)
buffer_load_dwordx4 v5, s[44:47], s93 offen offset:0  lds
s_waitcnt vmcnt(5)
buffer_load_dwordx4 v6, s[44:47], s93 offen offset:1024  lds
s_waitcnt vmcnt(5)
buffer_load_dwordx4 v7, s[44:47], s93 offen offset:2048  lds
s_waitcnt vmcnt(5)
buffer_load_dwordx4 v8, s[44:47], s93 offen offset:3072  lds
s_waitcnt vmcnt(0)
s_waitcnt lgkmcnt(0)
v_mfma_f32_32x32x16_bf16 v[62:77], v[46:49], v[150:153], v[62:77]
ds_read_b64_tr_b16 v[30:31], v17 offset:0
s_add_u32 m0, s60, 4096
s_add_u32 s93, s68, 5
s_and_b32 s93, s93, 7
s_lshl_b32 s93, s93, 16
s_add_u32 s93, s93, s70
buffer_load_dwordx4 v5, s[44:47], s93 offen offset:0  lds
ds_read_b64_tr_b16 v[32:33], v18 offset:0
buffer_load_dwordx4 v6, s[44:47], s93 offen offset:1024  lds
v_mfma_f32_32x32x16_bf16 v[78:93], v[50:53], v[150:153], v[78:93]
ds_read_b64_tr_b16 v[34:35], v19 offset:0
buffer_load_dwordx4 v7, s[44:47], s93 offen offset:2048  lds
ds_read_b64_tr_b16 v[36:37], v20 offset:0
buffer_load_dwordx4 v8, s[44:47], s93 offen offset:3072  lds
v_mfma_f32_32x32x16_bf16 v[62:77], v[54:57], v[154:157], v[62:77]
ds_read_b64_tr_b16 v[38:39], v17 offset:2048
s_add_u32 m0, s60, 8192
s_add_u32 s93, s68, 6
s_and_b32 s93, s93, 7
s_lshl_b32 s93, s93, 16
s_add_u32 s93, s93, s70
buffer_load_dwordx4 v5, s[44:47], s93 offen offset:0  lds
ds_read_b64_tr_b16 v[40:41], v18 offset:2048
buffer_load_dwordx4 v6, s[44:47], s93 offen offset:1024  lds
v_mfma_f32_32x32x16_bf16 v[78:93], v[58:61], v[154:157], v[78:93]
ds_read_b64_tr_b16 v[42:43], v19 offset:2048
buffer_load_dwordx4 v7, s[44:47], s93 offen offset:2048  lds
ds_read_b64_tr_b16 v[44:45], v20 offset:2048
buffer_load_dwordx4 v8, s[44:47], s93 offen offset:3072  lds
s_waitcnt vmcnt(4)
s_waitcnt lgkmcnt(0)
v_mfma_f32_32x32x16_bf16 v[62:77], v[30:33], v[158:161], v[62:77]
ds_read_b64_tr_b16 v[46:47], v17 offset:4096
ds_read_b64_tr_b16 v[48:49], v18 offset:4096
s_add_u32 m0, s60, 12288
s_add_u32 s93, s68, 7
s_and_b32 s93, s93, 7
s_lshl_b32 s93, s93, 16
s_add_u32 s93, s93, s70
buffer_load_dwordx4 v5, s[44:47], s93 offen offset:0  lds
v_mfma_f32_32x32x16_bf16 v[78:93], v[34:37], v[158:161], v[78:93]
ds_read_b64_tr_b16 v[50:51], v19 offset:4096
ds_read_b64_tr_b16 v[52:53], v20 offset:4096
buffer_load_dwordx4 v6, s[44:47], s93 offen offset:1024  lds
v_mfma_f32_32x32x16_bf16 v[62:77], v[38:41], v[162:165], v[62:77]
ds_read_b64_tr_b16 v[54:55], v17 offset:6144
ds_read_b64_tr_b16 v[56:57], v18 offset:6144
buffer_load_dwordx4 v7, s[44:47], s93 offen offset:2048  lds
v_mfma_f32_32x32x16_bf16 v[78:93], v[42:45], v[162:165], v[78:93]
ds_read_b64_tr_b16 v[58:59], v19 offset:6144
ds_read_b64_tr_b16 v[60:61], v20 offset:6144
buffer_load_dwordx4 v8, s[44:47], s93 offen offset:3072  lds
s_waitcnt vmcnt(4)
v_and_b32 v12, 3, v0
v_lshlrev_b32 v12, 3, v12
v_bfe_u32 v254, v0, 2, 2
v_lshl_add_u32 v12, v254, 7, v12
v_bfe_u32 v254, v0, 4, 2
v_lshl_add_u32 v12, v254, 12, v12
buffer_load_dwordx2 v[10:11], v12, s[56:59], s65 offen sc1
s_waitcnt lgkmcnt(0)
v_mfma_f32_32x32x16_bf16 v[62:77], v[46:49], v[166:169], v[62:77]
ds_read_b64_tr_b16 v[30:31], v17 offset:8192
ds_read_b64_tr_b16 v[32:33], v18 offset:8192
v_mfma_f32_32x32x16_bf16 v[78:93], v[50:53], v[166:169], v[78:93]
ds_read_b64_tr_b16 v[34:35], v19 offset:8192
ds_read_b64_tr_b16 v[36:37], v20 offset:8192
v_mfma_f32_32x32x16_bf16 v[62:77], v[54:57], v[170:173], v[62:77]
ds_read_b64_tr_b16 v[38:39], v17 offset:10240
ds_read_b64_tr_b16 v[40:41], v18 offset:10240
v_mfma_f32_32x32x16_bf16 v[78:93], v[58:61], v[170:173], v[78:93]
ds_read_b64_tr_b16 v[42:43], v19 offset:10240
ds_read_b64_tr_b16 v[44:45], v20 offset:10240
s_waitcnt vmcnt(1)
s_waitcnt lgkmcnt(0)
v_mfma_f32_32x32x16_bf16 v[62:77], v[30:33], v[174:177], v[62:77]
ds_read_b64_tr_b16 v[46:47], v17 offset:12288
ds_read_b64_tr_b16 v[48:49], v18 offset:12288
v_mfma_f32_32x32x16_bf16 v[78:93], v[34:37], v[174:177], v[78:93]
ds_read_b64_tr_b16 v[50:51], v19 offset:12288
ds_read_b64_tr_b16 v[52:53], v20 offset:12288
v_mfma_f32_32x32x16_bf16 v[62:77], v[38:41], v[178:181], v[62:77]
ds_read_b64_tr_b16 v[54:55], v17 offset:14336
ds_read_b64_tr_b16 v[56:57], v18 offset:14336
v_mfma_f32_32x32x16_bf16 v[78:93], v[42:45], v[178:181], v[78:93]
ds_read_b64_tr_b16 v[58:59], v19 offset:14336
ds_read_b64_tr_b16 v[60:61], v20 offset:14336
s_waitcnt lgkmcnt(0)
v_mfma_f32_32x32x16_bf16 v[62:77], v[46:49], v[182:185], v[62:77]
v_mfma_f32_32x32x16_bf16 v[78:93], v[50:53], v[182:185], v[78:93]
v_mfma_f32_32x32x16_bf16 v[62:77], v[54:57], v[186:189], v[62:77]
v_mfma_f32_32x32x16_bf16 v[78:93], v[58:61], v[186:189], v[78:93]
s_waitcnt vmcnt(0)
s_mov_b32 s62, 0
s_nop 9
L_chk_23:
v_and_b32 v10, v10, v11
v_cmp_ne_u32 vcc, 1, v10
s_add_u32 s62, s62, 1
s_nop 2
s_cbranch_vccz L_ok_24
s_cmp_lt_u32 s62, 200000
s_cbranch_scc0 L_ok_24
s_sleep 8
buffer_load_dwordx2 v[10:11], v12, s[56:59], s65 offen sc1
s_waitcnt vmcnt(0)
s_branch L_chk_23
L_ok_24:
s_and_b32 s61, s3, 3
s_lshl_b32 s61, s61, 14
s_lshr_b32 s62, s3, 2
s_add_u32 s62, s62, 4
s_lshl_b32 s62, s62, 14
s_sub_u32 s62, s62, s60
v_add_u32 v226, s61, v25
v_add_u32 v230, s62, v17
v_add_u32 v231, s62, v18
v_add_u32 v232, s62, v19
v_add_u32 v233, s62, v20
s_add_u32 m0, s60, 0
s_cmp_lt_u32 s3, 4
s_cselect_b32 s96, s56, s24
s_cmp_lt_u32 s3, 4
s_cselect_b32 s97, s57, s25
s_cmp_lt_u32 s3, 4
s_cselect_b32 s98, s58, s26
s_mov_b32 s99, 0x20000
s_lshl_b32 s63, s4, 2
s_lshl_b32 s61, s64, 2
s_add_u32 s61, s61, s3
s_lshl_b32 s61, s61, 5
s_add_u32 s61, s61, s63
s_lshl_b32 s61, s61, 13
s_add_u32 s61, s61, 0
s_lshl_b32 s63, s63, 18
s_bfe_u32 s62, s3, 0x10001
s_lshl_b32 s62, s62, 16
s_add_u32 s63, s63, s62
s_and_b32 s62, s3, 1
s_lshl_b32 s62, s62, 7
s_add_u32 s63, s63, s62
s_lshl_b32 s62, s75, 8
s_add_u32 s63, s63, s62
s_lshl_b32 s78, s64, 2
s_add_u32 s78, s78, s75
s_cmp_lt_u32 s3, 4
s_cselect_b32 s76, s61, s63
s_cselect_b32 s77, 12, 17
s_cselect_b64 vcc, -1, 0
v_cndmask_b32 v222, v5, v25, vcc
v_cndmask_b32 v223, v6, v25, vcc
v_cndmask_b32 v224, v7, v25, vcc
v_cndmask_b32 v225, v8, v25, vcc
s_add_u32 s93, s78, 0
s_and_b32 s93, s93, 7
s_lshl_b32 s93, s93, s77
s_add_u32 s93, s93, s76
buffer_load_dwordx4 v222, s[96:99], s93 offen offset:0 sc1 lds
buffer_load_dwordx4 v223, s[96:99], s93 offen offset:1024 sc1 lds
buffer_load_dwordx4 v224, s[96:99], s93 offen offset:2048 sc1 lds
buffer_load_dwordx4 v225, s[96:99], s93 offen offset:3072 sc1 lds
s_add_u32 m0, s60, 4096
s_add_u32 s93, s78, 1
s_and_b32 s93, s93, 7
s_lshl_b32 s93, s93, s77
s_add_u32 s93, s93, s76
buffer_load_dwordx4 v222, s[96:99], s93 offen offset:0 sc1 lds
buffer_load_dwordx4 v223, s[96:99], s93 offen offset:1024 sc1 lds
buffer_load_dwordx4 v224, s[96:99], s93 offen offset:2048 sc1 lds
buffer_load_dwordx4 v225, s[96:99], s93 offen offset:3072 sc1 lds
s_add_u32 m0, s60, 8192
s_add_u32 s93, s78, 2
s_and_b32 s93, s93, 7
s_lshl_b32 s93, s93, s77
s_add_u32 s93, s93, s76
buffer_load_dwordx4 v222, s[96:99], s93 offen offset:0 sc1 lds
buffer_load_dwordx4 v223, s[96:99], s93 offen offset:1024 sc1 lds
buffer_load_dwordx4 v224, s[96:99], s93 offen offset:2048 sc1 lds
s_lshl_b32 s66, s64, 2
s_and_b32 s61, s3, 3
s_add_u32 s66, s66, s61
s_lshl_b32 s7, s75, 1
s_lshr_b32 s61, s3, 2
s_add_u32 s7, s7, s61
s_lshl_b32 s61, s66, 4
s_add_u32 s61, s61, s7
s_lshl_b32 s74, s61, 7
s_lshl_b32 s61, s61, 3
s_add_u32 s61, s61, s4
s_lshl_b32 s73, s61, 12
s_add_u32 s73, s73, 16777216
s_lshl_b32 s61, s4, 2
s_add_u32 s74, s74, s61
s_add_u32 s74, s74, 10616832
s_xor_b32 s82, s82, 16384
s_xor_b32 s83, s83, 256
s_xor_b32 s67, s67, 2
s_lshl_b32 s70, s3, 20
s_lshl_b32 s61, s81, 7
s_add_u32 s70, s70, s61
s_lshl_b32 s61, s67, 18
s_add_u32 s70, s70, s61
s_waitcnt vmcnt(7)
s_barrier
ds_read_b128 v[126:129], v226 offset:0
ds_read_b64_tr_b16 v[142:143], v230 offset:0
ds_read_b64_tr_b16 v[144:145], v231 offset:0
ds_read_b64_tr_b16 v[146:147], v232 offset:0
ds_read_b64_tr_b16 v[148:149], v233 offset:0
ds_read_b128 v[130:133], v226 offset:1024
ds_read_b64_tr_b16 v[150:151], v230 offset:2048
ds_read_b64_tr_b16 v[152:153], v231 offset:2048
ds_read_b64_tr_b16 v[154:155], v232 offset:2048
ds_read_b64_tr_b16 v[156:157], v233 offset:2048
ds_read_b128 v[134:137], v226 offset:2048
ds_read_b64_tr_b16 v[158:159], v230 offset:32768
s_waitcnt lgkmcnt(4)
ds_read_b64_tr_b16 v[160:161], v231 offset:32768
ds_read_b64_tr_b16 v[162:163], v232 offset:32768
ds_read_b64_tr_b16 v[164:165], v233 offset:32768
ds_read_b128 v[138:141], v226 offset:3072
ds_read_b64_tr_b16 v[166:167], v230 offset:34816
ds_read_b64_tr_b16 v[168:169], v231 offset:34816
ds_read_b64_tr_b16 v[170:171], v232 offset:34816
ds_read_b64_tr_b16 v[172:173], v233 offset:34816
s_waitcnt vmcnt(3)
s_waitcnt lgkmcnt(0)
s_barrier
v_mfma_f32_32x32x16_bf16 v[94:109], v[142:145], v[126:129], 0
buffer_load_dwordx4 v225, s[96:99], s93 offen offset:3072 sc1 lds
ds_read_b128 v[174:177], v226 offset:4096
ds_read_b64_tr_b16 v[190:191], v230 offset:4096
ds_read_b64_tr_b16 v[192:193], v231 offset:4096
ds_read_b64_tr_b16 v[194:195], v232 offset:4096
v_mfma_f32_32x32x16_bf16 v[110:125], v[146:149], v[126:129], 0
ds_read_b64_tr_b16 v[196:197], v233 offset:4096
s_add_u32 m0, s60, 12288
s_add_u32 s93, s78, 3
s_and_b32 s93, s93, 7
s_lshl_b32 s93, s93, s77
s_add_u32 s93, s93, s76
buffer_load_dwordx4 v222, s[96:99], s93 offen offset:0 sc1 lds
ds_read_b128 v[178:181], v226 offset:5120
ds_read_b64_tr_b16 v[198:199], v230 offset:6144
ds_read_b64_tr_b16 v[200:201], v231 offset:6144
v_mfma_f32_32x32x16_bf16 v[94:109], v[150:153], v[130:133], v[94:109]
ds_read_b64_tr_b16 v[202:203], v232 offset:6144
ds_read_b64_tr_b16 v[204:205], v233 offset:6144
buffer_load_dwordx4 v223, s[96:99], s93 offen offset:1024 sc1 lds
s_waitcnt lgkmcnt(5)
ds_read_b128 v[182:185], v226 offset:6144
v_mfma_f32_32x32x16_bf16 v[110:125], v[154:157], v[130:133], v[110:125]
ds_read_b64_tr_b16 v[206:207], v230 offset:36864
ds_read_b64_tr_b16 v[208:209], v231 offset:36864
ds_read_b64_tr_b16 v[210:211], v232 offset:36864
ds_read_b64_tr_b16 v[212:213], v233 offset:36864
buffer_load_dwordx4 v224, s[96:99], s93 offen offset:2048 sc1 lds
v_mfma_f32_32x32x16_bf16 v[94:109], v[158:161], v[134:137], v[94:109]
buffer_load_dwordx4 v225, s[96:99], s93 offen offset:3072 sc1 lds
ds_read_b128 v[186:189], v226 offset:7168
ds_read_b64_tr_b16 v[214:215], v230 offset:38912
ds_read_b64_tr_b16 v[216:217], v231 offset:38912
ds_read_b64_tr_b16 v[218:219], v232 offset:38912
ds_read_b64_tr_b16 v[220:221], v233 offset:38912
v_mfma_f32_32x32x16_bf16 v[110:125], v[162:165], v[134:137], v[110:125]
v_mfma_f32_32x32x16_bf16 v[94:109], v[166:169], v[138:141], v[94:109]
v_mfma_f32_32x32x16_bf16 v[110:125], v[170:173], v[138:141], v[110:125]
s_waitcnt vmcnt(4)
s_waitcnt lgkmcnt(0)
s_barrier
v_mfma_f32_32x32x16_bf16 v[94:109], v[190:193], v[174:177], v[94:109]
s_add_u32 m0, s60, 0
s_add_u32 s93, s78, 4
s_and_b32 s93, s93, 7
s_lshl_b32 s93, s93, s77
s_add_u32 s93, s93, s76
buffer_load_dwordx4 v222, s[96:99], s93 offen offset:0 sc1 lds
ds_read_b128 v[126:129], v226 offset:8192
ds_read_b64_tr_b16 v[142:143], v230 offset:8192
ds_read_b64_tr_b16 v[144:145], v231 offset:8192
ds_read_b64_tr_b16 v[146:147], v232 offset:8192
v_mfma_f32_32x32x16_bf16 v[110:125], v[194:197], v[174:177], v[110:125]
ds_read_b64_tr_b16 v[148:149], v233 offset:8192
buffer_load_dwordx4 v223, s[96:99], s93 offen offset:1024 sc1 lds
ds_read_b128 v[130:133], v226 offset:9216
ds_read_b64_tr_b16 v[150:151], v230 offset:10240
ds_read_b64_tr_b16 v[152:153], v231 offset:10240
v_mfma_f32_32x32x16_bf16 v[94:109], v[198:201], v[178:181], v[94:109]
ds_read_b64_tr_b16 v[154:155], v232 offset:10240
ds_read_b64_tr_b16 v[156:157], v233 offset:10240
buffer_load_dwordx4 v224, s[96:99], s93 offen offset:2048 sc1 lds
s_waitcnt lgkmcnt(5)
ds_read_b128 v[134:137], v226 offset:10240
v_mfma_f32_32x32x16_bf16 v[110:125], v[202:205], v[178:181], v[110:125]
ds_read_b64_tr_b16 v[158:159], v230 offset:40960
ds_read_b64_tr_b16 v[160:161], v231 offset:40960
ds_read_b64_tr_b16 v[162:163], v232 offset:40960
ds_read_b64_tr_b16 v[164:165], v233 offset:40960
buffer_load_dwordx4 v225, s[96:99], s93 offen offset:3072 sc1 lds
v_mfma_f32_32x32x16_bf16 v[94:109], v[206:209], v[182:185], v[94:109]
ds_read_b128 v[138:141], v226 offset:11264
ds_read_b64_tr_b16 v[166:167], v230 offset:43008
ds_read_b64_tr_b16 v[168:169], v231 offset:43008
ds_read_b64_tr_b16 v[170:171], v232 offset:43008
ds_read_b64_tr_b16 v[172:173], v233 offset:43008
v_mfma_f32_32x32x16_bf16 v[110:125], v[210:213], v[182:185], v[110:125]
v_mfma_f32_32x32x16_bf16 v[94:109], v[214:217], v[186:189], v[94:109]
v_mfma_f32_32x32x16_bf16 v[110:125], v[218:221], v[186:189], v[110:125]
s_waitcnt vmcnt(4)
s_waitcnt lgkmcnt(0)
s_barrier
v_mfma_f32_32x32x16_bf16 v[94:109], v[142:145], v[126:129], v[94:109]
s_add_u32 m0, s60, 4096
s_add_u32 s93, s78, 5
s_and_b32 s93, s93, 7
s_lshl_b32 s93, s93, s77
s_add_u32 s93, s93, s76
buffer_load_dwordx4 v222, s[96:99], s93 offen offset:0 sc1 lds
ds_read_b128 v[174:177], v226 offset:12288
ds_read_b64_tr_b16 v[190:191], v230 offset:12288
ds_read_b64_tr_b16 v[192:193], v231 offset:12288
ds_read_b64_tr_b16 v[194:195], v232 offset:12288
v_mfma_f32_32x32x16_bf16 v[110:125], v[146:149], v[126:129], v[110:125]
ds_read_b64_tr_b16 v[196:197], v233 offset:12288
buffer_load_dwordx4 v223, s[96:99], s93 offen offset:1024 sc1 lds
ds_read_b128 v[178:181], v226 offset:13312
ds_read_b64_tr_b16 v[198:199], v230 offset:14336
ds_read_b64_tr_b16 v[200:201], v231 offset:14336
v_mfma_f32_32x32x16_bf16 v[94:109], v[150:153], v[130:133], v[94:109]
ds_read_b64_tr_b16 v[202:203], v232 offset:14336
ds_read_b64_tr_b16 v[204:205], v233 offset:14336
buffer_load_dwordx4 v224, s[96:99], s93 offen offset:2048 sc1 lds
s_waitcnt lgkmcnt(5)
ds_read_b128 v[182:185], v226 offset:14336
v_mfma_f32_32x32x16_bf16 v[110:125], v[154:157], v[130:133], v[110:125]
ds_read_b64_tr_b16 v[206:207], v230 offset:45056
ds_read_b64_tr_b16 v[208:209], v231 offset:45056
ds_read_b64_tr_b16 v[210:211], v232 offset:45056
ds_read_b64_tr_b16 v[212:213], v233 offset:45056
buffer_load_dwordx4 v225, s[96:99], s93 offen offset:3072 sc1 lds
v_mfma_f32_32x32x16_bf16 v[94:109], v[158:161], v[134:137], v[94:109]
ds_read_b128 v[186:189], v226 offset:15360
ds_read_b64_tr_b16 v[214:215], v230 offset:47104
ds_read_b64_tr_b16 v[216:217], v231 offset:47104
ds_read_b64_tr_b16 v[218:219], v232 offset:47104
ds_read_b64_tr_b16 v[220:221], v233 offset:47104
v_mfma_f32_32x32x16_bf16 v[110:125], v[162:165], v[134:137], v[110:125]
v_mfma_f32_32x32x16_bf16 v[94:109], v[166:169], v[138:141], v[94:109]
v_mfma_f32_32x32x16_bf16 v[110:125], v[170:173], v[138:141], v[110:125]
s_waitcnt vmcnt(4)
s_waitcnt lgkmcnt(0)
s_barrier
v_mfma_f32_32x32x16_bf16 v[94:109], v[190:193], v[174:177], v[94:109]
s_add_u32 m0, s60, 8192
s_add_u32 s93, s78, 6
s_and_b32 s93, s93, 7
s_lshl_b32 s93, s93, s77
s_add_u32 s93, s93, s76
buffer_load_dwordx4 v222, s[96:99], s93 offen offset:0 sc1 lds
ds_read_b128 v[126:129], v226 offset:0
ds_read_b64_tr_b16 v[142:143], v230 offset:0
ds_read_b64_tr_b16 v[144:145], v231 offset:0
ds_read_b64_tr_b16 v[146:147], v232 offset:0
v_mfma_f32_32x32x16_bf16 v[110:125], v[194:197], v[174:177], v[110:125]
ds_read_b64_tr_b16 v[148:149], v233 offset:0
buffer_load_dwordx4 v223, s[96:99], s93 offen offset:1024 sc1 lds
ds_read_b128 v[130:133], v226 offset:1024
ds_read_b64_tr_b16 v[150:151], v230 offset:2048
ds_read_b64_tr_b16 v[152:153], v231 offset:2048
v_mfma_f32_32x32x16_bf16 v[94:109], v[198:201], v[178:181], v[94:109]
ds_read_b64_tr_b16 v[154:155], v232 offset:2048
ds_read_b64_tr_b16 v[156:157], v233 offset:2048
buffer_load_dwordx4 v224, s[96:99], s93 offen offset:2048 sc1 lds
s_waitcnt lgkmcnt(5)
ds_read_b128 v[134:137], v226 offset:2048
v_mfma_f32_32x32x16_bf16 v[110:125], v[202:205], v[178:181], v[110:125]
ds_read_b64_tr_b16 v[158:159], v230 offset:32768
ds_read_b64_tr_b16 v[160:161], v231 offset:32768
ds_read_b64_tr_b16 v[162:163], v232 offset:32768
ds_read_b64_tr_b16 v[164:165], v233 offset:32768
buffer_load_dwordx4 v225, s[96:99], s93 offen offset:3072 sc1 lds
v_mfma_f32_32x32x16_bf16 v[94:109], v[206:209], v[182:185], v[94:109]
ds_read_b128 v[138:141], v226 offset:3072
ds_read_b64_tr_b16 v[166:167], v230 offset:34816
ds_read_b64_tr_b16 v[168:169], v231 offset:34816
ds_read_b64_tr_b16 v[170:171], v232 offset:34816
ds_read_b64_tr_b16 v[172:173], v233 offset:34816
v_mfma_f32_32x32x16_bf16 v[110:125], v[210:213], v[182:185], v[110:125]
v_mfma_f32_32x32x16_bf16 v[94:109], v[214:217], v[186:189], v[94:109]
v_mfma_f32_32x32x16_bf16 v[110:125], v[218:221], v[186:189], v[110:125]
s_waitcnt vmcnt(4)
s_waitcnt lgkmcnt(0)
s_barrier
v_mfma_f32_32x32x16_bf16 v[94:109], v[142:145], v[126:129], v[94:109]
s_add_u32 m0, s60, 12288
s_add_u32 s93, s78, 7
s_and_b32 s93, s93, 7
s_lshl_b32 s93, s93, s77
s_add_u32 s93, s93, s76
buffer_load_dwordx4 v222, s[96:99], s93 offen offset:0 sc1 lds
ds_read_b128 v[174:177], v226 offset:4096
ds_read_b64_tr_b16 v[190:191], v230 offset:4096
ds_read_b64_tr_b16 v[192:193], v231 offset:4096
ds_read_b64_tr_b16 v[194:195], v232 offset:4096
v_mfma_f32_32x32x16_bf16 v[110:125], v[146:149], v[126:129], v[110:125]
ds_read_b64_tr_b16 v[196:197], v233 offset:4096
buffer_load_dwordx4 v223, s[96:99], s93 offen offset:1024 sc1 lds
ds_read_b128 v[178:181], v226 offset:5120
ds_read_b64_tr_b16 v[198:199], v230 offset:6144
ds_read_b64_tr_b16 v[200:201], v231 offset:6144
v_mfma_f32_32x32x16_bf16 v[94:109], v[150:153], v[130:133], v[94:109]
ds_read_b64_tr_b16 v[202:203], v232 offset:6144
ds_read_b64_tr_b16 v[204:205], v233 offset:6144
buffer_load_dwordx4 v224, s[96:99], s93 offen offset:2048 sc1 lds
s_waitcnt lgkmcnt(5)
ds_read_b128 v[182:185], v226 offset:6144
v_mfma_f32_32x32x16_bf16 v[110:125], v[154:157], v[130:133], v[110:125]
ds_read_b64_tr_b16 v[206:207], v230 offset:36864
ds_read_b64_tr_b16 v[208:209], v231 offset:36864
ds_read_b64_tr_b16 v[210:211], v232 offset:36864
ds_read_b64_tr_b16 v[212:213], v233 offset:36864
buffer_load_dwordx4 v225, s[96:99], s93 offen offset:3072 sc1 lds
v_mfma_f32_32x32x16_bf16 v[94:109], v[158:161], v[134:137], v[94:109]
ds_read_b128 v[186:189], v226 offset:7168
ds_read_b64_tr_b16 v[214:215], v230 offset:38912
ds_read_b64_tr_b16 v[216:217], v231 offset:38912
ds_read_b64_tr_b16 v[218:219], v232 offset:38912
ds_read_b64_tr_b16 v[220:221], v233 offset:38912
v_mfma_f32_32x32x16_bf16 v[110:125], v[162:165], v[134:137], v[110:125]
v_mfma_f32_32x32x16_bf16 v[94:109], v[166:169], v[138:141], v[94:109]
v_mfma_f32_32x32x16_bf16 v[110:125], v[170:173], v[138:141], v[110:125]
s_waitcnt vmcnt(4)
s_waitcnt lgkmcnt(0)
s_barrier
v_mfma_f32_32x32x16_bf16 v[94:109], v[190:193], v[174:177], v[94:109]
s_add_u32 m0, s60, 0
s_add_u32 s93, s68, 0
s_and_b32 s93, s93, 7
s_lshl_b32 s93, s93, 16
s_add_u32 s93, s93, s70
buffer_load_dwordx4 v5, s[44:47], s93 offen offset:0  lds
ds_read_b128 v[126:129], v226 offset:8192
ds_read_b64_tr_b16 v[142:143], v230 offset:8192
ds_read_b64_tr_b16 v[144:145], v231 offset:8192
ds_read_b64_tr_b16 v[146:147], v232 offset:8192
v_mfma_f32_32x32x16_bf16 v[110:125], v[194:197], v[174:177], v[110:125]
ds_read_b64_tr_b16 v[148:149], v233 offset:8192
buffer_load_dwordx4 v6, s[44:47], s93 offen offset:1024  lds
ds_read_b128 v[130:133], v226 offset:9216
ds_read_b64_tr_b16 v[150:151], v230 offset:10240
ds_read_b64_tr_b16 v[152:153], v231 offset:10240
v_mfma_f32_32x32x16_bf16 v[94:109], v[198:201], v[178:181], v[94:109]
ds_read_b64_tr_b16 v[154:155], v232 offset:10240
ds_read_b64_tr_b16 v[156:157], v233 offset:10240
buffer_load_dwordx4 v7, s[44:47], s93 offen offset:2048  lds
s_waitcnt lgkmcnt(5)
ds_read_b128 v[134:137], v226 offset:10240
v_mfma_f32_32x32x16_bf16 v[110:125], v[202:205], v[178:181], v[110:125]
ds_read_b64_tr_b16 v[158:159], v230 offset:40960
ds_read_b64_tr_b16 v[160:161], v231 offset:40960
ds_read_b64_tr_b16 v[162:163], v232 offset:40960
ds_read_b64_tr_b16 v[164:165], v233 offset:40960
buffer_load_dwordx4 v8, s[44:47], s93 offen offset:3072  lds
v_mfma_f32_32x32x16_bf16 v[94:109], v[206:209], v[182:185], v[94:109]
ds_read_b128 v[138:141], v226 offset:11264
ds_read_b64_tr_b16 v[166:167], v230 offset:43008
ds_read_b64_tr_b16 v[168:169], v231 offset:43008
ds_read_b64_tr_b16 v[170:171], v232 offset:43008
ds_read_b64_tr_b16 v[172:173], v233 offset:43008
v_mfma_f32_32x32x16_bf16 v[110:125], v[210:213], v[182:185], v[110:125]
v_mfma_f32_32x32x16_bf16 v[94:109], v[214:217], v[186:189], v[94:109]
v_mfma_f32_32x32x16_bf16 v[110:125], v[218:221], v[186:189], v[110:125]
s_waitcnt vmcnt(4)
s_waitcnt lgkmcnt(0)
s_barrier
v_mfma_f32_32x32x16_bf16 v[94:109], v[142:145], v[126:129], v[94:109]
s_add_u32 m0, s60, 4096
s_add_u32 s93, s68, 1
s_and_b32 s93, s93, 7
s_lshl_b32 s93, s93, 16
s_add_u32 s93, s93, s70
buffer_load_dwordx4 v5, s[44:47], s93 offen offset:0  lds
ds_read_b128 v[174:177], v226 offset:12288
ds_read_b64_tr_b16 v[190:191], v230 offset:12288
ds_read_b64_tr_b16 v[192:193], v231 offset:12288
ds_read_b64_tr_b16 v[194:195], v232 offset:12288
v_mfma_f32_32x32x16_bf16 v[110:125], v[146:149], v[126:129], v[110:125]
ds_read_b64_tr_b16 v[196:197], v233 offset:12288
buffer_load_dwordx4 v6, s[44:47], s93 offen offset:1024  lds
ds_read_b128 v[178:181], v226 offset:13312
ds_read_b64_tr_b16 v[198:199], v230 offset:14336
ds_read_b64_tr_b16 v[200:201], v231 offset:14336
v_mfma_f32_32x32x16_bf16 v[94:109], v[150:153], v[130:133], v[94:109]
ds_read_b64_tr_b16 v[202:203], v232 offset:14336
ds_read_b64_tr_b16 v[204:205], v233 offset:14336
buffer_load_dwordx4 v7, s[44:47], s93 offen offset:2048  lds
s_waitcnt lgkmcnt(5)
ds_read_b128 v[182:185], v226 offset:14336
v_mfma_f32_32x32x16_bf16 v[110:125], v[154:157], v[130:133], v[110:125]
ds_read_b64_tr_b16 v[206:207], v230 offset:45056
ds_read_b64_tr_b16 v[208:209], v231 offset:45056
ds_read_b64_tr_b16 v[210:211], v232 offset:45056
ds_read_b64_tr_b16 v[212:213], v233 offset:45056
buffer_load_dwordx4 v8, s[44:47], s93 offen offset:3072  lds
v_mfma_f32_32x32x16_bf16 v[94:109], v[158:161], v[134:137], v[94:109]
ds_read_b128 v[186:189], v226 offset:15360
ds_read_b64_tr_b16 v[214:215], v230 offset:47104
ds_read_b64_tr_b16 v[216:217], v231 offset:47104
ds_read_b64_tr_b16 v[218:219], v232 offset:47104
ds_read_b64_tr_b16 v[220:221], v233 offset:47104
v_mfma_f32_32x32x16_bf16 v[110:125], v[162:165], v[134:137], v[110:125]
v_mfma_f32_32x32x16_bf16 v[94:109], v[166:169], v[138:141], v[94:109]
v_mfma_f32_32x32x16_bf16 v[110:125], v[170:173], v[138:141], v[110:125]
s_waitcnt lgkmcnt(0)
s_barrier
v_mfma_f32_32x32x16_bf16 v[94:109], v[190:193], v[174:177], v[94:109]
v_mfma_f32_32x32x16_bf16 v[110:125], v[194:197], v[174:177], v[110:125]
v_mfma_f32_32x32x16_bf16 v[94:109], v[198:201], v[178:181], v[94:109]
v_mfma_f32_32x32x16_bf16 v[110:125], v[202:205], v[178:181], v[110:125]
v_mfma_f32_32x32x16_bf16 v[94:109], v[206:209], v[182:185], v[94:109]
v_mfma_f32_32x32x16_bf16 v[110:125], v[210:213], v[182:185], v[110:125]
v_mfma_f32_32x32x16_bf16 v[94:109], v[214:217], v[186:189], v[94:109]
v_mfma_f32_32x32x16_bf16 v[110:125], v[218:221], v[186:189], v[110:125]
s_nop 10
v_cvt_pk_bf16_f32 v46, v94, v95
v_cvt_pk_bf16_f32 v47, v96, v97
v_cvt_pk_bf16_f32 v48, v98, v99
v_cvt_pk_bf16_f32 v49, v100, v101
v_cvt_pk_bf16_f32 v50, v102, v103
v_cvt_pk_bf16_f32 v51, v104, v105
v_cvt_pk_bf16_f32 v52, v106, v107
v_cvt_pk_bf16_f32 v53, v108, v109
v_cvt_pk_bf16_f32 v54, v110, v111
v_cvt_pk_bf16_f32 v55, v112, v113
v_cvt_pk_bf16_f32 v56, v114, v115
v_cvt_pk_bf16_f32 v57, v116, v117
v_cvt_pk_bf16_f32 v58, v118, v119
v_cvt_pk_bf16_f32 v59, v120, v121
v_cvt_pk_bf16_f32 v60, v122, v123
v_cvt_pk_bf16_f32 v61, v124, v125
buffer_store_dwordx4 v[46:49], v25, s[56:59], s73 offen offset:0 sc1
buffer_store_dwordx4 v[50:53], v25, s[56:59], s73 offen offset:1024 sc1
buffer_store_dwordx4 v[54:57], v25, s[56:59], s73 offen offset:2048 sc1
buffer_store_dwordx4 v[58:61], v25, s[56:59], s73 offen offset:3072 sc1
s_add_u32 m0, s60, 8192
s_add_u32 s93, s68, 2
s_and_b32 s93, s93, 7
s_lshl_b32 s93, s93, 16
s_add_u32 s93, s93, s70
s_waitcnt vmcnt(5)
buffer_load_dwordx4 v5, s[44:47], s93 offen offset:0  lds
ds_read_b64_tr_b16 v[126:127], v17 offset:0
ds_read_b64_tr_b16 v[128:129], v18 offset:0
ds_read_b64_tr_b16 v[130:131], v19 offset:0
ds_read_b64_tr_b16 v[132:133], v20 offset:0
ds_read_b64_tr_b16 v[134:135], v17 offset:2048
ds_read_b64_tr_b16 v[136:137], v18 offset:2048
ds_read_b64_tr_b16 v[138:139], v19 offset:2048
ds_read_b64_tr_b16 v[140:141], v20 offset:2048
s_waitcnt lgkmcnt(0)
s_waitcnt vmcnt(5)
buffer_load_dwordx4 v6, s[44:47], s93 offen offset:1024  lds
ds_read_b64_tr_b16 v[142:143], v17 offset:4096
ds_read_b64_tr_b16 v[144:145], v18 offset:4096
ds_read_b64_tr_b16 v[146:147], v19 offset:4096
ds_read_b64_tr_b16 v[148:149], v20 offset:4096
ds_read_b64_tr_b16 v[150:151], v17 offset:6144
ds_read_b64_tr_b16 v[152:153], v18 offset:6144
ds_read_b64_tr_b16 v[154:155], v19 offset:6144
ds_read_b64_tr_b16 v[156:157], v20 offset:6144
s_waitcnt lgkmcnt(0)
s_waitcnt vmcnt(5)
buffer_load_dwordx4 v7, s[44:47], s93 offen offset:2048  lds
s_waitcnt vmcnt(5)
buffer_load_dwordx4 v8, s[44:47], s93 offen offset:3072  lds
s_add_u32 m0, s60, 12288
s_add_u32 s93, s68, 3
s_and_b32 s93, s93, 7
s_lshl_b32 s93, s93, 16
s_add_u32 s93, s93, s70
s_waitcnt vmcnt(5)
buffer_load_dwordx4 v5, s[44:47], s93 offen offset:0  lds
s_waitcnt vmcnt(5)
buffer_load_dwordx4 v6, s[44:47], s93 offen offset:1024  lds
s_waitcnt vmcnt(5)
buffer_load_dwordx4 v7, s[44:47], s93 offen offset:2048  lds
s_waitcnt vmcnt(5)
buffer_load_dwordx4 v8, s[44:47], s93 offen offset:3072  lds
s_add_u32 m0, s60, 0
s_add_u32 s93, s68, 4
s_and_b32 s93, s93, 7
s_lshl_b32 s93, s93, 16
s_add_u32 s93, s93, s70
s_waitcnt vmcnt(5)
buffer_load_dwordx4 v5, s[44:47], s93 offen offset:0  lds
s_waitcnt vmcnt(5)
buffer_load_dwordx4 v6, s[44:47], s93 offen offset:1024  lds
ds_read_b64_tr_b16 v[158:159], v17 offset:8192
ds_read_b64_tr_b16 v[160:161], v18 offset:8192
ds_read_b64_tr_b16 v[162:163], v19 offset:8192
ds_read_b64_tr_b16 v[164:165], v20 offset:8192
ds_read_b64_tr_b16 v[166:167], v17 offset:10240
ds_read_b64_tr_b16 v[168:169], v18 offset:10240
ds_read_b64_tr_b16 v[170:171], v19 offset:10240
ds_read_b64_tr_b16 v[172:173], v20 offset:10240
s_waitcnt lgkmcnt(0)
s_waitcnt vmcnt(5)
buffer_load_dwordx4 v7, s[44:47], s93 offen offset:2048  lds
s_waitcnt vmcnt(5)
buffer_load_dwordx4 v8, s[44:47], s93 offen offset:3072  lds
s_add_u32 m0, s60, 4096
s_add_u32 s93, s68, 5
s_and_b32 s93, s93, 7
s_lshl_b32 s93, s93, 16
s_add_u32 s93, s93, s70
s_waitcnt vmcnt(5)
buffer_load_dwordx4 v5, s[44:47], s93 offen offset:0  lds
s_waitcnt vmcnt(5)
buffer_load_dwordx4 v6, s[44:47], s93 offen offset:1024  lds
v_mov_b32 v254, 1
s_mov_b64 exec, 1
buffer_store_dword v254, off, s[56:59], s74 offset:0 sc1
s_mov_b64 exec, -1
ds_read_b64_tr_b16 v[174:175], v17 offset:12288
ds_read_b64_tr_b16 v[176:177], v18 offset:12288
ds_read_b64_tr_b16 v[178:179], v19 offset:12288
ds_read_b64_tr_b16 v[180:181], v20 offset:12288
ds_read_b64_tr_b16 v[182:183], v17 offset:14336
ds_read_b64_tr_b16 v[184:185], v18 offset:14336
ds_read_b64_tr_b16 v[186:187], v19 offset:14336
ds_read_b64_tr_b16 v[188:189], v20 offset:14336
s_waitcnt lgkmcnt(0)
s_waitcnt vmcnt(5)
buffer_load_dwordx4 v7, s[44:47], s93 offen offset:2048  lds
s_waitcnt vmcnt(5)
buffer_load_dwordx4 v8, s[44:47], s93 offen offset:3072  lds
s_add_u32 m0, s60, 8192
s_add_u32 s93, s68, 6
s_and_b32 s93, s93, 7
s_lshl_b32 s93, s93, 16
s_add_u32 s93, s93, s70
s_waitcnt vmcnt(5)
buffer_load_dwordx4 v5, s[44:47], s93 offen offset:0  lds
ds_read_b64_tr_b16 v[190:191], v17 offset:0
ds_read_b64_tr_b16 v[192:193], v18 offset:0
ds_read_b64_tr_b16 v[194:195], v19 offset:0
ds_read_b64_tr_b16 v[196:197], v20 offset:0
ds_read_b64_tr_b16 v[198:199], v17 offset:2048
ds_read_b64_tr_b16 v[200:201], v18 offset:2048
ds_read_b64_tr_b16 v[202:203], v19 offset:2048
ds_read_b64_tr_b16 v[204:205], v20 offset:2048
s_waitcnt lgkmcnt(0)
s_waitcnt vmcnt(5)
buffer_load_dwordx4 v6, s[44:47], s93 offen offset:1024  lds
s_waitcnt vmcnt(5)
buffer_load_dwordx4 v7, s[44:47], s93 offen offset:2048  lds
s_waitcnt vmcnt(5)
buffer_load_dwordx4 v8, s[44:47], s93 offen offset:3072  lds
s_add_u32 m0, s60, 12288
s_add_u32 s93, s68, 7
s_and_b32 s93, s93, 7
s_lshl_b32 s93, s93, 16
s_add_u32 s93, s93, s70
s_waitcnt vmcnt(5)
buffer_load_dwordx4 v5, s[44:47], s93 offen offset:0  lds
s_waitcnt vmcnt(5)
buffer_load_dwordx4 v6, s[44:47], s93 offen offset:1024  lds
ds_read_b64_tr_b16 v[206:207], v17 offset:4096
ds_read_b64_tr_b16 v[208:209], v18 offset:4096
ds_read_b64_tr_b16 v[210:211], v19 offset:4096
ds_read_b64_tr_b16 v[212:213], v20 offset:4096
ds_read_b64_tr_b16 v[214:215], v17 offset:6144
ds_read_b64_tr_b16 v[216:217], v18 offset:6144
ds_read_b64_tr_b16 v[218:219], v19 offset:6144
ds_read_b64_tr_b16 v[220:221], v20 offset:6144
s_waitcnt lgkmcnt(0)
s_waitcnt vmcnt(5)
buffer_load_dwordx4 v7, s[44:47], s93 offen offset:2048  lds
s_waitcnt vmcnt(5)
buffer_load_dwordx4 v8, s[44:47], s93 offen offset:3072  lds
s_waitcnt vmcnt(4)
ds_read_b64_tr_b16 v[222:223], v17 offset:8192
ds_read_b64_tr_b16 v[224:225], v18 offset:8192
ds_read_b64_tr_b16 v[226:227], v19 offset:8192
ds_read_b64_tr_b16 v[228:229], v20 offset:8192
ds_read_b64_tr_b16 v[230:231], v17 offset:10240
ds_read_b64_tr_b16 v[232:233], v18 offset:10240
ds_read_b64_tr_b16 v[234:235], v19 offset:10240
ds_read_b64_tr_b16 v[236:237], v20 offset:10240
s_waitcnt lgkmcnt(0)
s_waitcnt vmcnt(0)
ds_read_b64_tr_b16 v[238:239], v17 offset:12288
ds_read_b64_tr_b16 v[240:241], v18 offset:12288
ds_read_b64_tr_b16 v[242:243], v19 offset:12288
ds_read_b64_tr_b16 v[244:245], v20 offset:12288
ds_read_b64_tr_b16 v[246:247], v17 offset:14336
ds_read_b64_tr_b16 v[248:249], v18 offset:14336
ds_read_b64_tr_b16 v[250:251], v19 offset:14336
ds_read_b64_tr_b16 v[252:253], v20 offset:14336
s_waitcnt lgkmcnt(0)
v_and_b32 v12, 7, v0
v_lshlrev_b32 v12, 2, v12
v_bfe_u32 v254, v0, 3, 1
v_lshl_add_u32 v12, v254, 7, v12
buffer_load_dword v10, v12, s[56:59], s83 offen sc1
v_lshrrev_b32 v255, 5, v0
v_and_b32 v21, 31, v0
v_xor_b32 v21, v21, v255
v_lshlrev_b32 v21, 4, v21
v_lshlrev_b32 v255, 9, v255
v_add3_u32 v21, v21, v255, s60
v_lshrrev_b32 v24, 4, v0
s_lshl_b32 s61, s3, 2
v_add_u32 v24, s61, v24
v_and_b32 v255, 15, v0
v_xor_b32 v22, v24, v255
v_lshlrev_b32 v22, 4, v22
v_lshl_add_u32 v22, v255, 9, v22
v_add_u32 v23, 0x10000, v22
v_lshlrev_b32 v24, 12, v24
v_lshl_add_u32 v24, v255, 3, v24
s_waitcnt vmcnt(0)
s_mov_b32 s62, 0
s_nop 4
L_chk_25:
v_cmp_ne_u32 vcc, 1, v10
s_add_u32 s62, s62, 1
s_nop 2
s_cbranch_vccz L_ok_26
s_cmp_lt_u32 s62, 200000
s_cbranch_scc0 L_ok_26
s_sleep 2
buffer_load_dword v10, v12, s[56:59], s83 offen sc1
s_waitcnt vmcnt(0)
s_branch L_chk_25
L_ok_26:
s_add_u32 s89, s68, 0
s_and_b32 s89, s89, 7
s_lshl_b32 s89, s89, 11
s_add_u32 s89, s89, s82
buffer_load_dwordx4 v[94:97], v25, s[56:59], s89 offen offset:0 sc1
buffer_load_dwordx4 v[98:101], v25, s[56:59], s89 offen offset:1024 sc1
s_add_u32 s89, s68, 1
s_and_b32 s89, s89, 7
s_lshl_b32 s89, s89, 11
s_add_u32 s89, s89, s82
buffer_load_dwordx4 v[102:105], v25, s[56:59], s89 offen offset:0 sc1
buffer_load_dwordx4 v[106:109], v25, s[56:59], s89 offen offset:1024 sc1
s_add_u32 s89, s68, 2
s_and_b32 s89, s89, 7
s_lshl_b32 s89, s89, 11
s_add_u32 s89, s89, s82
buffer_load_dwordx4 v[110:113], v25, s[56:59], s89 offen offset:0 sc1
buffer_load_dwordx4 v[114:117], v25, s[56:59], s89 offen offset:1024 sc1
s_add_u32 s89, s68, 3
s_and_b32 s89, s89, 7
s_lshl_b32 s89, s89, 11
s_add_u32 s89, s89, s82
buffer_load_dwordx4 v[118:121], v25, s[56:59], s89 offen offset:0 sc1
buffer_load_dwordx4 v[122:125], v25, s[56:59], s89 offen offset:1024 sc1
s_add_u32 s89, s68, 4
s_and_b32 s89, s89, 7
s_lshl_b32 s89, s89, 11
s_add_u32 s89, s89, s82
buffer_load_dwordx4 v[30:33], v25, s[56:59], s89 offen offset:0 sc1
buffer_load_dwordx4 v[34:37], v25, s[56:59], s89 offen offset:1024 sc1
s_add_u32 s89, s68, 5
s_and_b32 s89, s89, 7
s_lshl_b32 s89, s89, 11
s_add_u32 s89, s89, s82
buffer_load_dwordx4 v[38:41], v25, s[56:59], s89 offen offset:0 sc1
buffer_load_dwordx4 v[42:45], v25, s[56:59], s89 offen offset:1024 sc1
s_add_u32 s89, s68, 6
s_and_b32 s89, s89, 7
s_lshl_b32 s89, s89, 11
s_add_u32 s89, s89, s82
buffer_load_dwordx4 v[46:49], v25, s[56:59], s89 offen offset:0 sc1
buffer_load_dwordx4 v[50:53], v25, s[56:59], s89 offen offset:1024 sc1
s_add_u32 s89, s68, 7
s_and_b32 s89, s89, 7
s_lshl_b32 s89, s89, 11
s_add_u32 s89, s89, s82
buffer_load_dwordx4 v[54:57], v25, s[56:59], s89 offen offset:0 sc1
buffer_load_dwordx4 v[58:61], v25, s[56:59], s89 offen offset:1024 sc1
s_waitcnt vmcnt(15)
v_mfma_f32_32x32x16_bf16 v[62:77], v[126:129], v[94:97], v[62:77]
v_mfma_f32_32x32x16_bf16 v[78:93], v[130:133], v[94:97], v[78:93]
s_waitcnt vmcnt(14)
v_mfma_f32_32x32x16_bf16 v[62:77], v[134:137], v[98:101], v[62:77]
v_mfma_f32_32x32x16_bf16 v[78:93], v[138:141], v[98:101], v[78:93]
s_waitcnt vmcnt(13)
v_mfma_f32_32x32x16_bf16 v[62:77], v[142:145], v[102:105], v[62:77]
v_mfma_f32_32x32x16_bf16 v[78:93], v[146:149], v[102:105], v[78:93]
s_waitcnt vmcnt(12)
v_mfma_f32_32x32x16_bf16 v[62:77], v[150:153], v[106:109], v[62:77]
v_mfma_f32_32x32x16_bf16 v[78:93], v[154:157], v[106:109], v[78:93]
s_waitcnt vmcnt(11)
v_mfma_f32_32x32x16_bf16 v[62:77], v[158:161], v[110:113], v[62:77]
v_mfma_f32_32x32x16_bf16 v[78:93], v[162:165], v[110:113], v[78:93]
s_waitcnt vmcnt(10)
v_mfma_f32_32x32x16_bf16 v[62:77], v[166:169], v[114:117], v[62:77]
v_mfma_f32_32x32x16_bf16 v[78:93], v[170:173], v[114:117], v[78:93]
s_waitcnt vmcnt(9)
v_mfma_f32_32x32x16_bf16 v[62:77], v[174:177], v[118:121], v[62:77]
v_mfma_f32_32x32x16_bf16 v[78:93], v[178:181], v[118:121], v[78:93]
s_waitcnt vmcnt(8)
v_mfma_f32_32x32x16_bf16 v[62:77], v[182:185], v[122:125], v[62:77]
v_mfma_f32_32x32x16_bf16 v[78:93], v[186:189], v[122:125], v[78:93]
s_waitcnt vmcnt(7)
v_mfma_f32_32x32x16_bf16 v[62:77], v[190:193], v[30:33], v[62:77]
v_mfma_f32_32x32x16_bf16 v[78:93], v[194:197], v[30:33], v[78:93]
s_waitcnt vmcnt(6)
v_mfma_f32_32x32x16_bf16 v[62:77], v[198:201], v[34:37], v[62:77]
v_mfma_f32_32x32x16_bf16 v[78:93], v[202:205], v[34:37], v[78:93]
s_waitcnt vmcnt(5)
v_mfma_f32_32x32x16_bf16 v[62:77], v[206:209], v[38:41], v[62:77]
v_mfma_f32_32x32x16_bf16 v[78:93], v[210:213], v[38:41], v[78:93]
s_waitcnt vmcnt(4)
v_mfma_f32_32x32x16_bf16 v[62:77], v[214:217], v[42:45], v[62:77]
v_mfma_f32_32x32x16_bf16 v[78:93], v[218:221], v[42:45], v[78:93]
s_waitcnt vmcnt(3)
v_mfma_f32_32x32x16_bf16 v[62:77], v[222:225], v[46:49], v[62:77]
v_mfma_f32_32x32x16_bf16 v[78:93], v[226:229], v[46:49], v[78:93]
s_waitcnt vmcnt(2)
v_mfma_f32_32x32x16_bf16 v[62:77], v[230:233], v[50:53], v[62:77]
v_mfma_f32_32x32x16_bf16 v[78:93], v[234:237], v[50:53], v[78:93]
s_waitcnt vmcnt(1)
v_mfma_f32_32x32x16_bf16 v[62:77], v[238:241], v[54:57], v[62:77]
v_mfma_f32_32x32x16_bf16 v[78:93], v[242:245], v[54:57], v[78:93]
s_waitcnt vmcnt(0)
v_mfma_f32_32x32x16_bf16 v[62:77], v[246:249], v[58:61], v[62:77]
v_mfma_f32_32x32x16_bf16 v[78:93], v[250:253], v[58:61], v[78:93]
v_xor_b32 v31, 32, v21
v_xor_b32 v32, 64, v21
v_xor_b32 v33, 96, v21
v_xor_b32 v34, 128, v21
v_xor_b32 v35, 160, v21
v_xor_b32 v36, 192, v21
v_xor_b32 v37, 224, v21
s_nop 3
ds_write_b128 v21, v[62:65] offset:0
ds_write_b128 v31, v[66:69] offset:1024
ds_write_b128 v32, v[70:73] offset:2048
ds_write_b128 v33, v[74:77] offset:3072
ds_write_b128 v34, v[78:81] offset:4096
ds_write_b128 v35, v[82:85] offset:5120
ds_write_b128 v36, v[86:89] offset:6144
ds_write_b128 v37, v[90:93] offset:7168
s_waitcnt lgkmcnt(0)
s_barrier
ds_read_b128 v[126:129], v22 offset:0
ds_read_b128 v[130:133], v22 offset:16384
ds_read_b128 v[134:137], v22 offset:32768
ds_read_b128 v[138:141], v22 offset:49152
ds_read_b128 v[142:145], v23 offset:0
ds_read_b128 v[146:149], v23 offset:16384
ds_read_b128 v[150:153], v23 offset:32768
ds_read_b128 v[154:157], v23 offset:49152
s_waitcnt lgkmcnt(6)
v_add_f32 v126, v126, v130
v_add_f32 v127, v127, v131
v_add_f32 v128, v128, v132
v_add_f32 v129, v129, v133
s_waitcnt lgkmcnt(5)
v_add_f32 v126, v126, v134
v_add_f32 v127, v127, v135
v_add_f32 v128, v128, v136
v_add_f32 v129, v129, v137
s_waitcnt lgkmcnt(4)
v_add_f32 v126, v126, v138
v_add_f32 v127, v127, v139
v_add_f32 v128, v128, v140
v_add_f32 v129, v129, v141
s_waitcnt lgkmcnt(3)
v_add_f32 v126, v126, v142
v_add_f32 v127, v127, v143
v_add_f32 v128, v128, v144
v_add_f32 v129, v129, v145
s_waitcnt lgkmcnt(2)
v_add_f32 v126, v126, v146
v_add_f32 v127, v127, v147
v_add_f32 v128, v128, v148
v_add_f32 v129, v129, v149
s_waitcnt lgkmcnt(1)
v_add_f32 v126, v126, v150
v_add_f32 v127, v127, v151
v_add_f32 v128, v128, v152
v_add_f32 v129, v129, v153
s_waitcnt lgkmcnt(0)
v_add_f32 v126, v126, v154
v_add_f32 v127, v127, v155
v_add_f32 v128, v128, v156
v_add_f32 v129, v129, v157
v_cvt_pk_bf16_f32 v130, v126, v127
v_cvt_pk_bf16_f32 v131, v128, v129
buffer_store_dwordx2 v[130:131], v24, s[48:51], s6 offen
s_endpgm
L_end:
s_endpgm
.section .rodata,"a"
.p2align 6
.amdhsa_kernel concat_heads__gqa_block_cached__mha_block_cached__near_ridge_kernel
  .amdhsa_next_free_vgpr 256
  .amdhsa_next_free_sgpr 102
  .amdhsa_accum_offset 256
  .amdhsa_group_segment_fixed_size 0
  .amdhsa_kernarg_size 104
  .amdhsa_user_sgpr_count 2
  .amdhsa_user_sgpr_kernarg_segment_ptr 1
  .amdhsa_system_sgpr_workgroup_id_x 1
.end_amdhsa_kernel
```
